```python
import torch

def _softmax(x, axis=-1):
    return torch.softmax(x, dim=axis)
def _gelu(x):
    return torch.nn.functional.gelu(x, approximate="tanh")
def _silu(x):
    return torch.nn.functional.silu(x)
def _sigmoid(x):
    return torch.sigmoid(x)
def _layernorm(x, axis=-1, eps=1e-5):
    m = x.mean(dim=axis, keepdim=True)
    v = x.var(dim=axis, keepdim=True, unbiased=False)
    return (x - m) / torch.sqrt(v + eps)
def _scatter_add(tgt, idx, src, axis=0):
    return tgt.clone().index_add_(axis, idx, src)
def _segment_sum(src, seg, n):
    out = torch.zeros((n,) + src.shape[1:], dtype=src.dtype)
    return out.index_add_(0, seg, src)
def _pad(x, pw):
    flat = tuple(v for pair in reversed(pw) for v in pair)
    return torch.nn.functional.pad(x, flat)

kernel_name = 'parallel_sum__linear_kernel_hedgehog__glu_gated_swiglu__prompt'

def setup_inputs():

    _w = (lambda a: (lambda t: t.to(torch.bfloat16) if t.is_floating_point() else t)(torch.as_tensor(a)))
    def _A_setup():
        B, S, D, H = 1, 2048, 512, 32
        Dh = D // H
        return {
            "x": _w((lambda *s: torch.randn(*s, dtype=torch.bfloat16) * 0.05)(B, S, D)),
            "wqkv": _w((lambda *s: torch.randn(*s, dtype=torch.bfloat16) * 0.2)(D, 3 * D)),
            "w_phi": _w((lambda *s: torch.randn(*s, dtype=torch.bfloat16) * 0.2)(H, Dh, Dh) * (Dh ** -0.5)),
            "wo": _w((lambda *s: torch.randn(*s, dtype=torch.bfloat16) * 0.05)(D, D)),
        }
    _A_in = _A_setup()

    def _B_setup():
        B, S, D, F = 1, 2048, 512, 1376
        return {
            "x": _w((lambda *s: torch.randn(*s, dtype=torch.bfloat16) * 0.05)(B, S, D)),
            "w1": _w((lambda *s: torch.randn(*s, dtype=torch.bfloat16) * 0.4)(D, F) * (2.0 / D) ** 0.5),
            "w3": _w((lambda *s: torch.randn(*s, dtype=torch.bfloat16) * 0.4)(D, F) * (2.0 / D) ** 0.5),
            "w2": _w((lambda *s: torch.randn(*s, dtype=torch.bfloat16) * 0.4)(F, D) * (2.0 / F) ** 0.5),
        }
    _B_in = _B_setup()

    return {
        "A_x": _A_in["x"],
        "A_wqkv": _A_in["wqkv"],
        "A_w_phi": _A_in["w_phi"],
        "A_wo": _A_in["wo"],
        "B_x": _B_in["x"],
        "B_w1": _B_in["w1"],
        "B_w3": _B_in["w3"],
        "B_w2": _B_in["w2"],
    }

def reference(A_x, A_wqkv, A_w_phi, A_wo, B_x, B_w1, B_w3, B_w2):
    def _A_ref(x, wqkv, w_phi, wo):
        B, S, D = x.shape
        H = 32; Dh = D // H
        qkv = (lambda x, *d: x.permute(*d))((x @ wqkv).reshape(B, S, 3, H, Dh), 2, 0, 3, 1, 4)
        q, k, v = qkv[0], qkv[1], qkv[2]
        pq = torch.einsum("bhsd,hdf->bhsf", q, w_phi)
        pk = torch.einsum("bhsd,hdf->bhsf", k, w_phi)
        phi_q = torch.concatenate([_softmax(pq, axis=-1), _softmax(-pq, axis=-1)], axis=-1)
        phi_k = torch.concatenate([_softmax(pk, axis=-1), _softmax(-pk, axis=-1)], axis=-1)
        kv = torch.einsum("bhsf,bhsd->bhfd", phi_k, v)
        z  = torch.einsum("bhsf->bhf", phi_k)
        num = torch.einsum("bhqf,bhfd->bhqd", phi_q, kv)
        den = torch.einsum("bhqf,bhf->bhq", phi_q, z)[..., None] + 1e-6
        o = num / den
        return (lambda x, *d: x.permute(*d))(o, 0, 2, 1, 3).reshape(B, S, D) @ wo

    def _B_ref(x, w1, w3, w2):
        gate = torch.einsum("bsd,df->bsf", x, w1)
        up = torch.einsum("bsd,df->bsf", x, w3)
        h = _silu(gate) * up
        out = torch.einsum("bsf,fd->bsd", h, w2)
        return out

    x = A_x
    xn = _layernorm(x, axis=-1)
    return x + _A_ref(xn, A_wqkv, A_w_phi, A_wo) + _B_ref(xn, B_w1, B_w3, B_w2)
```

```asm
; @launch grid=(256,1,1) block=(512,1,1) lds=163840
.amdgcn_target "amdgcn-amd-amdhsa--gfx950"
.text
.globl parallel_sum__linear_kernel_hedgehog__glu_gated_swiglu__prompt_kernel
.p2align 8
.type parallel_sum__linear_kernel_hedgehog__glu_gated_swiglu__prompt_kernel,@function
parallel_sum__linear_kernel_hedgehog__glu_gated_swiglu__prompt_kernel:
  s_cmp_ge_u32 s2, 256
  s_cbranch_scc1 parallel_sum__linear_kernel_hedgehog__glu_gated_swiglu__prompt_kernel_end
  s_load_dwordx16 s[4:19], s[0:1], 0
  s_load_dwordx4 s[20:23], s[0:1], 64
  s_load_dwordx2 s[24:25], s[0:1], 80
  v_lshrrev_b32 v2, 6, v0
  v_and_b32 v0, 63, v0
  s_getreg_b32 s68, hwreg(HW_REG_XCC_ID)
  v_readfirstlane_b32 s60, v2
  s_and_b32 s68, s68, 7
  s_lshr_b32 s70, s2, 6
  v_mov_b32 v4, 0
  v_lshlrev_b32 v1, 4, v0
  s_cmp_lg_u32 s60, 0
  s_lshl_b32 s66, s60, 8
  s_add_u32 s66, s66, s2
  s_cmp_eq_u32 s66, 0
  s_cbranch_scc1 ALrare_1
ALback_2:
  s_nop 0
  s_and_b32 s66, s2, 7
  s_lshr_b32 s67, s2, 3
  s_and_b32 s68, s67, 7
  s_and_b32 s63, s66, 1
  s_lshl_b32 s63, s63, 3
  s_add_u32 s63, s63, s68
  s_and_b32 s64, s66, 6
  s_and_b32 s69, s70, 1
  s_add_u32 s64, s64, s69
  s_lshr_b32 s66, s66, 1
  s_lshl_b32 s69, s69, 2
  s_add_u32 s65, s66, s69
  s_and_b32 s69, s70, 2
  s_add_u32 s65, s65, s69
  s_add_u32 s65, s65, s68
  s_and_b32 s65, s65, 7
  s_and_b32 s64, s2, 7
  s_and_b32 s63, s67, 15
  s_lshl_b32 s65, s70, 1
  s_and_b32 s65, s65, 4
  s_add_u32 s65, s65, s64
  s_add_u32 s65, s65, s68
  s_and_b32 s65, s65, 7
  s_and_b32 s61, s60, 3
  s_lshr_b32 s62, s60, 2
  s_cmp_lg_u32 s60, 7
  s_cbranch_scc1 ALskip_3
  s_getpc_b64 s[96:97]
ALpc_4:
  s_lshl_b32 s66, s67, 11
  v_lshlrev_b32 v7, 7, v0
  v_add_u32 v7, s66, v7
  v_min_u32 v7, parallel_sum__linear_kernel_hedgehog__glu_gated_swiglu__prompt_kernel_last-ALpc_4, v7
  s_mov_b64 exec, 0xffff
  global_load_dword v9, v7, s[96:97]
  s_mov_b64 exec, -1
ALskip_3:
  s_lshl_b32 s66, s70, 1
  s_add_u32 s66, s66, s62
  s_cmp_ge_u32 s70, 2
  s_cbranch_scc1 parallel_sum__linear_kernel_hedgehog__glu_gated_swiglu__prompt_kernel_proF
parallel_sum__linear_kernel_hedgehog__glu_gated_swiglu__prompt_kernel_proA:
  s_lshl_b32 s66, s63, 3
  s_add_u32 s66, s66, s60
  s_lshl_b32 s66, s66, 14
  v_lshrrev_b32 v2, 3, v0
  v_lshlrev_b32 v3, 10, v2
  v_add_u32 v3, s66, v3
  v_and_b32 v4, 7, v0
  v_lshrrev_b32 v5, 4, v0
  v_xor_b32 v5, v4, v5
  v_lshl_add_u32 v10, v5, 4, v3
  v_xor_b32 v3, 64, v10
  v_add_u32 v11, 7168, v3
  s_lshl_b32 s66, s60, 3
  v_add_u32 v2, s66, v2
  v_mul_u32_u24 v2, 3072, v2
  v_bfe_u32 v3, v0, 4, 1
  v_lshlrev_b32 v3, 2, v3
  v_xor_b32 v3, v3, v4
  v_lshl_add_u32 v2, v3, 4, v2
  s_lshl_b32 s66, s64, 7
  v_add_u32 v12, s66, v2
  s_lshl_b32 s76, s60, 11
  s_lshl_b32 s77, s60, 10
  s_waitcnt lgkmcnt(0)
  s_mov_b32 s32, s4
  s_mov_b32 s33, s5
  s_mov_b32 s34, 2097152
  s_mov_b32 s35, 0x20000
  s_mov_b32 s48, s6
  s_mov_b32 s49, s7
  s_mov_b32 s50, 1572864
  s_mov_b32 s51, 0x20000
  s_add_u32 s71, s65, 0
  s_and_b32 s71, s71, 7
  s_lshl_b32 s72, s71, 7
  s_add_u32 m0, s76, 0
  s_mul_i32 s73, s71, 196608
  buffer_load_dwordx4 v10, s[32:35], s72 offen lds
  buffer_load_dwordx4 v11, s[32:35], s72 offen offset:1024 lds
  s_add_u32 m0, s77, 15360
  s_add_u32 s85, s73, 2048
  buffer_load_dwordx4 v12, s[48:51], s73 offen offset:1024 lds
  s_add_u32 m0, s77, 24576
  s_nop 0
  buffer_load_dwordx4 v12, s[48:51], s85 offen lds
  s_branch parallel_sum__linear_kernel_hedgehog__glu_gated_swiglu__prompt_kernel_bodyA
parallel_sum__linear_kernel_hedgehog__glu_gated_swiglu__prompt_kernel_proF:
  s_mul_i32 s87, s64, 288
  s_add_u32 s87, s87, 512
  s_min_u32 s87, s87, 2464
  s_and_b32 s68, s61, 1
  s_add_u32 s68, s68, 4
  s_cmp_eq_u32 s62, 0
  s_cselect_b32 s68, s61, s68
  s_mul_i32 s68, s68, 3
  s_lshl_b32 s66, s68, 6
  v_add_u32 v5, s66, v0
  v_add_u32 v2, 0, v5
  v_mul_u32_u24 v3, 3641, v2
  v_lshrrev_b32 v3, 16, v3
  v_mul_u32_u24 v4, 2464, v3
  v_lshl_add_u32 v2, v2, 4, v4
  s_sub_u32 s66, s87, 0
  v_add_u32 v10, s66, v2
  v_add_u32 v2, 64, v5
  v_mul_u32_u24 v3, 3641, v2
  v_lshrrev_b32 v3, 16, v3
  v_mul_u32_u24 v4, 2464, v3
  v_lshl_add_u32 v2, v2, 4, v4
  s_sub_u32 s66, s87, 1024
  v_add_u32 v11, s66, v2
  v_add_u32 v2, 128, v5
  v_mul_u32_u24 v3, 3641, v2
  v_lshrrev_b32 v3, 16, v3
  v_mul_u32_u24 v4, 2464, v3
  v_lshl_add_u32 v2, v2, 4, v4
  s_sub_u32 s66, s87, 2048
  v_add_u32 v12, s66, v2
  s_lshl_b32 s66, s63, 2
  s_add_u32 s66, s66, s61
  s_lshl_b32 s66, s66, 15
  v_lshrrev_b32 v2, 3, v0
  v_lshlrev_b32 v2, 10, v2
  v_add_u32 v2, s66, v2
  v_and_b32 v3, 7, v0
  v_lshrrev_b32 v4, 4, v0
  v_xor_b32 v3, v3, v4
  v_lshl_add_u32 v13, v3, 4, v2
  v_xor_b32 v2, 64, v13
  v_add_u32 v14, 7168, v2
  v_add_u32 v15, 14336, v13
  v_add_u32 v16, 21504, v2
  s_lshl_b32 s68, s68, 10
  s_add_u32 s76, s68, 16384
  s_add_u32 s77, s68, 34944
  s_lshr_b32 s66, s60, 1
  s_cmp_eq_u32 s66, 2
  s_cselect_b32 s77, s76, s77
  s_lshl_b32 s66, s61, 12
  s_cmp_eq_u32 s62, 0
  s_cselect_b32 s76, s76, s66
  s_mov_b32 s71, s65
  s_lshl_b32 s72, s71, 7
  s_mul_i32 s73, s71, 176128
  s_mov_b32 s74, 0
  s_mov_b32 s80, 0
  s_mov_b32 s38, 1409024
  s_mov_b32 s39, 0x20000
  s_mov_b32 s42, 1409024
  s_mov_b32 s43, 0x20000
  s_mov_b32 s46, 1409024
  s_mov_b32 s47, 0x20000
  s_mov_b32 s34, 2097152
  s_mov_b32 s35, 0x20000
  s_cmp_lt_u32 s61, 2
  s_waitcnt lgkmcnt(0)
  s_cselect_b64 s[44:45], s[14:15], s[16:17]
  s_mov_b64 s[36:37], s[14:15]
  s_mov_b64 s[40:41], s[16:17]
  s_mov_b64 s[32:33], s[4:5]
  s_cmp_lg_u32 s62, 0
  s_cbranch_scc1 parallel_sum__linear_kernel_hedgehog__glu_gated_swiglu__prompt_kernel_proF1
parallel_sum__linear_kernel_hedgehog__glu_gated_swiglu__prompt_kernel_proF0:
  s_add_u32 m0, s74, s76
  s_nop 0
  buffer_load_dwordx4 v10, s[36:39], s73 offen offset:0 lds
  buffer_load_dwordx4 v11, s[36:39], s73 offen offset:1024 lds
  buffer_load_dwordx4 v12, s[36:39], s73 offen offset:2048 lds
  s_add_u32 m0, s74, s77
  s_nop 0
  buffer_load_dwordx4 v10, s[40:43], s73 offen offset:0 lds
  buffer_load_dwordx4 v11, s[40:43], s73 offen offset:1024 lds
  buffer_load_dwordx4 v12, s[40:43], s73 offen offset:2048 lds
  s_add_u32 s71, s71, 1
  s_and_b32 s71, s71, 7
  s_lshl_b32 s72, s71, 7
  s_mul_i32 s73, s71, 176128
  s_add_u32 s74, s74, 53376
  s_cmp_ge_u32 s74, 160128
  s_cselect_b32 s74, 0, s74
  s_add_u32 s80, s80, 1
  s_branch parallel_sum__linear_kernel_hedgehog__glu_gated_swiglu__prompt_kernel_bodyF0
parallel_sum__linear_kernel_hedgehog__glu_gated_swiglu__prompt_kernel_proF1:
  s_add_u32 m0, s74, s76
  s_nop 0
  buffer_load_dwordx4 v13, s[32:35], s72 offen offset:0 lds
  buffer_load_dwordx4 v14, s[32:35], s72 offen offset:1024 lds
  buffer_load_dwordx4 v15, s[32:35], s72 offen offset:2048 lds
  buffer_load_dwordx4 v16, s[32:35], s72 offen offset:3072 lds
  s_add_u32 m0, s74, s77
  s_nop 0
  buffer_load_dwordx4 v10, s[44:47], s73 offen offset:0 lds
  buffer_load_dwordx4 v11, s[44:47], s73 offen offset:1024 lds
  buffer_load_dwordx4 v12, s[44:47], s73 offen offset:2048 lds
  s_add_u32 s71, s71, 1
  s_and_b32 s71, s71, 7
  s_lshl_b32 s72, s71, 7
  s_mul_i32 s73, s71, 176128
  s_add_u32 s74, s74, 53376
  s_cmp_ge_u32 s74, 160128
  s_cselect_b32 s74, 0, s74
  s_add_u32 s80, s80, 1
  s_branch parallel_sum__linear_kernel_hedgehog__glu_gated_swiglu__prompt_kernel_bodyF1
parallel_sum__linear_kernel_hedgehog__glu_gated_swiglu__prompt_kernel_bodyF0:
  s_add_u32 m0, s74, s76
  s_nop 0
  buffer_load_dwordx4 v10, s[36:39], s73 offen offset:0 lds
  buffer_load_dwordx4 v11, s[36:39], s73 offen offset:1024 lds
  buffer_load_dwordx4 v12, s[36:39], s73 offen offset:2048 lds
  s_add_u32 m0, s74, s77
  s_nop 0
  buffer_load_dwordx4 v10, s[40:43], s73 offen offset:0 lds
  buffer_load_dwordx4 v11, s[40:43], s73 offen offset:1024 lds
  buffer_load_dwordx4 v12, s[40:43], s73 offen offset:2048 lds
  s_add_u32 s71, s71, 1
  s_and_b32 s71, s71, 7
  s_lshl_b32 s72, s71, 7
  s_mul_i32 s73, s71, 176128
  s_add_u32 s74, s74, 53376
  s_cmp_ge_u32 s74, 160128
  s_cselect_b32 s74, 0, s74
  s_add_u32 s80, s80, 1
  v_and_b32 v2, 31, v0
  v_lshlrev_b32 v3, 7, v2
  s_lshl_b32 s66, s61, 12
  v_add_u32 v3, s66, v3
  v_bfe_u32 v2, v0, 1, 3
  v_lshrrev_b32 v4, 5, v0
  v_xor_b32 v2, v2, v4
  v_lshl_add_u32 v3, v2, 4, v3
  s_add_u32 s66, s61, 0
  s_and_b32 s66, s66, 3
  s_lshl_b32 s66, s66, 5
  v_xor_b32 v17, s66, v3
  s_add_u32 s66, s61, 1
  s_and_b32 s66, s66, 3
  s_lshl_b32 s66, s66, 5
  v_xor_b32 v18, s66, v3
  s_add_u32 s66, s61, 2
  s_and_b32 s66, s66, 3
  s_lshl_b32 s66, s66, 5
  v_xor_b32 v19, s66, v3
  s_add_u32 s66, s61, 3
  s_and_b32 s66, s66, 3
  s_lshl_b32 s66, s66, 5
  v_xor_b32 v20, s66, v3
  v_bfe_u32 v2, v0, 4, 1
  v_mul_u32_u24 v2, 18560, v2
  v_lshrrev_b32 v3, 5, v0
  v_bfe_u32 v4, v0, 2, 2
  v_lshl_add_u32 v3, v3, 3, v4
  v_mul_u32_u24 v3, 288, v3
  v_add_u32 v2, v2, v3
  v_and_b32 v3, 3, v0
  v_lshl_add_u32 v2, v3, 3, v2
  v_add_u32 v5, 16384, v2
  s_lshl_b32 s66, s60, 5
  s_add_u32 s66, s66, 16384
  v_add_u32 v182, s66, v2
  s_add_u32 s66, s61, 0
  s_and_b32 s66, s66, 3
  s_mul_i32 s66, s66, 4608
  v_add_u32 v21, s66, v5
  s_add_u32 s66, s61, 1
  s_and_b32 s66, s66, 3
  s_mul_i32 s66, s66, 4608
  v_add_u32 v22, s66, v5
  s_add_u32 s66, s61, 2
  s_and_b32 s66, s66, 3
  s_mul_i32 s66, s66, 4608
  v_add_u32 v23, s66, v5
  s_add_u32 s66, s61, 3
  s_and_b32 s66, s66, 3
  s_mul_i32 s66, s66, 4608
  v_add_u32 v24, s66, v5
  v_mov_b64 v[28:29], 0
  v_mov_b64 v[30:31], 0
  v_mov_b64 v[32:33], 0
  v_mov_b64 v[34:35], 0
  v_mov_b64 v[36:37], 0
  v_mov_b64 v[38:39], 0
  v_mov_b64 v[40:41], 0
  v_mov_b64 v[42:43], 0
  v_mov_b64 v[44:45], 0
  v_mov_b64 v[46:47], 0
  v_mov_b64 v[48:49], 0
  v_mov_b64 v[50:51], 0
  v_mov_b64 v[52:53], 0
  v_mov_b64 v[54:55], 0
  v_mov_b64 v[56:57], 0
  v_mov_b64 v[58:59], 0
  v_mov_b64 v[60:61], 0
  v_mov_b64 v[62:63], 0
  v_mov_b64 v[64:65], 0
  v_mov_b64 v[66:67], 0
  v_mov_b64 v[68:69], 0
  v_mov_b64 v[70:71], 0
  v_mov_b64 v[72:73], 0
  v_mov_b64 v[74:75], 0
  v_mov_b64 v[76:77], 0
  v_mov_b64 v[78:79], 0
  v_mov_b64 v[80:81], 0
  v_mov_b64 v[82:83], 0
  v_mov_b64 v[84:85], 0
  v_mov_b64 v[86:87], 0
  v_mov_b64 v[88:89], 0
  v_mov_b64 v[90:91], 0
  v_mov_b64 v[92:93], 0
  v_mov_b64 v[94:95], 0
  v_mov_b64 v[96:97], 0
  v_mov_b64 v[98:99], 0
  v_mov_b64 v[100:101], 0
  v_mov_b64 v[102:103], 0
  v_mov_b64 v[104:105], 0
  v_mov_b64 v[106:107], 0
  v_mov_b32 v200, 0
  v_mov_b32 v201, 0
  v_mov_b32 v202, 0
  v_mov_b32 v203, 0
  v_mov_b32 v217, 0
  v_mov_b32 v218, 0
  v_mov_b32 v219, 0
  v_mov_b32 v221, 0
  v_mov_b32 v222, 0
  v_mov_b32 v223, 0
  s_mov_b32 s28, s24
  s_mov_b32 s29, s25
  s_mov_b32 s30, 16777216
  s_mov_b32 s31, 0x20000
  s_mov_b32 s56, s22
  s_mov_b32 s57, s23
  s_mov_b32 s58, 256
  s_mov_b32 s59, 0x20000
  s_cmp_lg_u32 s60, 6
  s_cbranch_scc1 ALskip_5
  v_lshlrev_b32 v7, 20, v0
  s_mov_b64 exec, 0xffff
  buffer_load_dword v9, v7, s[28:31], 0 offen sc1
  s_mov_b64 exec, 3
  global_load_dword v9, v7, s[20:21]
  global_load_dword v9, v7, s[18:19]
  s_mov_b64 exec, 1
  global_load_dword v9, v7, s[10:11]
  s_mov_b64 exec, -1
ALskip_5:
  s_lshl_b32 s66, s63, 2
  s_add_u32 s66, s66, s61
  s_lshl_b32 s88, s66, 12
  s_add_u32 s88, s88, 14942208
  s_lshl_b32 s92, s60, 8
  s_lshl_b32 s93, s64, 1
  s_lshr_b32 s66, s63, 3
  s_add_u32 s93, s93, s66
  s_lshl_b32 s93, s93, 15
  s_add_u32 s93, s93, 16252928
  s_lshl_b32 s79, s63, 2
  s_add_u32 s79, s79, s61
  s_mul_i32 s79, s79, 118
  s_lshr_b32 s67, s87, 5
  s_add_u32 s79, s79, s67
  s_add_u32 s79, s79, 0
  s_lshl_b32 s79, s79, 10
  s_mov_b32 s75, 0
  s_mov_b32 s86, 0
  s_mov_b32 s69, 53376
  s_lshl_b32 s94, s60, 11
  s_add_u32 s94, s94, s93
  s_waitcnt vmcnt(6)
  s_barrier
  v_mov_b32 v2, 0
  buffer_load_dwordx2 v[180:181], v2, s[56:59], 0 offen offset:128 sc1
  ds_read_b64_tr_b16 v[132:133], v182 offset:0
  ds_read_b64_tr_b16 v[134:135], v182 offset:1152
  ds_read_b64_tr_b16 v[136:137], v182 offset:4608
  ds_read_b64_tr_b16 v[138:139], v182 offset:5760
  ds_read_b64_tr_b16 v[140:141], v182 offset:9216
  ds_read_b64_tr_b16 v[142:143], v182 offset:10368
  ds_read_b64_tr_b16 v[144:145], v182 offset:13824
  ds_read_b64_tr_b16 v[146:147], v182 offset:14976
  s_add_u32 m0, s74, s76
  s_nop 0
  buffer_load_dwordx4 v10, s[36:39], s73 offen offset:0 lds
  buffer_load_dwordx4 v11, s[36:39], s73 offen offset:1024 lds
  s_waitcnt lgkmcnt(7)
  v_lshlrev_b32 v2, 16, v132
  v_and_b32 v3, 0xffff0000, v132
  v_lshlrev_b32 v4, 16, v133
  v_and_b32 v5, 0xffff0000, v133
  v_pk_add_f32 v[6:7], v[2:3], v[4:5]
  s_waitcnt lgkmcnt(6)
  v_lshlrev_b32 v2, 16, v134
  v_and_b32 v3, 0xffff0000, v134
  v_lshlrev_b32 v4, 16, v135
  v_and_b32 v5, 0xffff0000, v135
  v_pk_add_f32 v[6:7], v[6:7], v[2:3]
  v_pk_add_f32 v[6:7], v[6:7], v[4:5]
  s_waitcnt lgkmcnt(5)
  v_lshlrev_b32 v2, 16, v136
  v_and_b32 v3, 0xffff0000, v136
  v_lshlrev_b32 v4, 16, v137
  v_and_b32 v5, 0xffff0000, v137
  v_pk_add_f32 v[6:7], v[6:7], v[2:3]
  v_pk_add_f32 v[6:7], v[6:7], v[4:5]
  s_waitcnt lgkmcnt(4)
  v_lshlrev_b32 v2, 16, v138
  v_and_b32 v3, 0xffff0000, v138
  v_lshlrev_b32 v4, 16, v139
  v_and_b32 v5, 0xffff0000, v139
  v_pk_add_f32 v[6:7], v[6:7], v[2:3]
  v_pk_add_f32 v[6:7], v[6:7], v[4:5]
  s_waitcnt lgkmcnt(3)
  v_lshlrev_b32 v2, 16, v140
  v_and_b32 v3, 0xffff0000, v140
  v_lshlrev_b32 v4, 16, v141
  v_and_b32 v5, 0xffff0000, v141
  v_pk_add_f32 v[6:7], v[6:7], v[2:3]
  v_pk_add_f32 v[6:7], v[6:7], v[4:5]
  s_waitcnt lgkmcnt(2)
  v_lshlrev_b32 v2, 16, v142
  v_and_b32 v3, 0xffff0000, v142
  v_lshlrev_b32 v4, 16, v143
  v_and_b32 v5, 0xffff0000, v143
  v_pk_add_f32 v[6:7], v[6:7], v[2:3]
  v_pk_add_f32 v[6:7], v[6:7], v[4:5]
  s_waitcnt lgkmcnt(1)
  v_lshlrev_b32 v2, 16, v144
  v_and_b32 v3, 0xffff0000, v144
  v_lshlrev_b32 v4, 16, v145
  v_and_b32 v5, 0xffff0000, v145
  v_pk_add_f32 v[6:7], v[6:7], v[2:3]
  v_pk_add_f32 v[6:7], v[6:7], v[4:5]
  s_waitcnt lgkmcnt(0)
  v_lshlrev_b32 v2, 16, v146
  v_and_b32 v3, 0xffff0000, v146
  v_lshlrev_b32 v4, 16, v147
  v_and_b32 v5, 0xffff0000, v147
  v_pk_add_f32 v[6:7], v[6:7], v[2:3]
  v_pk_add_f32 v[6:7], v[6:7], v[4:5]
  v_add_f32 v6, v6, v7
  v_mov_b32 v7, v6
  s_nop 1
  v_permlane32_swap_b32 v6, v7
  v_add_f32 v176, v6, v7
  s_cmp_lg_u32 s60, 0
  s_cbranch_scc1 ALskip_6
  ds_read_b64_tr_b16 v[132:133], v182 offset:256
  ds_read_b64_tr_b16 v[134:135], v182 offset:1408
  ds_read_b64_tr_b16 v[136:137], v182 offset:4864
  ds_read_b64_tr_b16 v[138:139], v182 offset:6016
  ds_read_b64_tr_b16 v[140:141], v182 offset:9472
  ds_read_b64_tr_b16 v[142:143], v182 offset:10624
  ds_read_b64_tr_b16 v[144:145], v182 offset:14080
  ds_read_b64_tr_b16 v[146:147], v182 offset:15232
  s_waitcnt lgkmcnt(7)
  v_lshlrev_b32 v2, 16, v132
  v_and_b32 v3, 0xffff0000, v132
  v_lshlrev_b32 v4, 16, v133
  v_and_b32 v5, 0xffff0000, v133
  v_pk_add_f32 v[6:7], v[2:3], v[4:5]
  s_waitcnt lgkmcnt(6)
  v_lshlrev_b32 v2, 16, v134
  v_and_b32 v3, 0xffff0000, v134
  v_lshlrev_b32 v4, 16, v135
  v_and_b32 v5, 0xffff0000, v135
  v_pk_add_f32 v[6:7], v[6:7], v[2:3]
  v_pk_add_f32 v[6:7], v[6:7], v[4:5]
  s_waitcnt lgkmcnt(5)
  v_lshlrev_b32 v2, 16, v136
  v_and_b32 v3, 0xffff0000, v136
  v_lshlrev_b32 v4, 16, v137
  v_and_b32 v5, 0xffff0000, v137
  v_pk_add_f32 v[6:7], v[6:7], v[2:3]
  v_pk_add_f32 v[6:7], v[6:7], v[4:5]
  s_waitcnt lgkmcnt(4)
  v_lshlrev_b32 v2, 16, v138
  v_and_b32 v3, 0xffff0000, v138
  v_lshlrev_b32 v4, 16, v139
  v_and_b32 v5, 0xffff0000, v139
  v_pk_add_f32 v[6:7], v[6:7], v[2:3]
  v_pk_add_f32 v[6:7], v[6:7], v[4:5]
  s_waitcnt lgkmcnt(3)
  v_lshlrev_b32 v2, 16, v140
  v_and_b32 v3, 0xffff0000, v140
  v_lshlrev_b32 v4, 16, v141
  v_and_b32 v5, 0xffff0000, v141
  v_pk_add_f32 v[6:7], v[6:7], v[2:3]
  v_pk_add_f32 v[6:7], v[6:7], v[4:5]
  s_waitcnt lgkmcnt(2)
  v_lshlrev_b32 v2, 16, v142
  v_and_b32 v3, 0xffff0000, v142
  v_lshlrev_b32 v4, 16, v143
  v_and_b32 v5, 0xffff0000, v143
  v_pk_add_f32 v[6:7], v[6:7], v[2:3]
  v_pk_add_f32 v[6:7], v[6:7], v[4:5]
  s_waitcnt lgkmcnt(1)
  v_lshlrev_b32 v2, 16, v144
  v_and_b32 v3, 0xffff0000, v144
  v_lshlrev_b32 v4, 16, v145
  v_and_b32 v5, 0xffff0000, v145
  v_pk_add_f32 v[6:7], v[6:7], v[2:3]
  v_pk_add_f32 v[6:7], v[6:7], v[4:5]
  s_waitcnt lgkmcnt(0)
  v_lshlrev_b32 v2, 16, v146
  v_and_b32 v3, 0xffff0000, v146
  v_lshlrev_b32 v4, 16, v147
  v_and_b32 v5, 0xffff0000, v147
  v_pk_add_f32 v[6:7], v[6:7], v[2:3]
  v_pk_add_f32 v[6:7], v[6:7], v[4:5]
  v_add_f32 v6, v6, v7
  v_mov_b32 v7, v6
  s_nop 1
  v_permlane32_swap_b32 v6, v7
  v_add_f32 v178, v6, v7
ALskip_6:
  ds_read_b128 v[108:111], v17
  ds_read_b64_tr_b16 v[112:113], v21 offset:0
  ds_read_b64_tr_b16 v[114:115], v21 offset:1152
  ds_read_b64_tr_b16 v[116:117], v21 offset:32
  ds_read_b64_tr_b16 v[118:119], v21 offset:1184
  ds_read_b64_tr_b16 v[120:121], v21 offset:64
  ds_read_b64_tr_b16 v[122:123], v21 offset:1216
  ds_read_b64_tr_b16 v[124:125], v21 offset:96
  ds_read_b64_tr_b16 v[126:127], v21 offset:1248
  ds_read_b64_tr_b16 v[128:129], v21 offset:128
  ds_read_b64_tr_b16 v[130:131], v21 offset:1280
  s_mov_b32 s48, s18
  s_mov_b32 s49, s19
  s_mov_b32 s50, 1409024
  s_mov_b32 s51, 0x20000
  s_lshr_b32 s82, s2, 3
  s_and_b32 s82, s82, 15
  s_mul_i32 s82, s82, 86
  s_add_u32 s82, s82, s60
  s_lshl_b32 s82, s82, 10
parallel_sum__linear_kernel_hedgehog__glu_gated_swiglu__prompt_kernel_f0:
  s_waitcnt lgkmcnt(8)
  v_mfma_f32_32x32x16_bf16 v[28:43], v[112:115], v[108:111], v[28:43]
  ds_read_b128 v[132:135], v18
  ds_read_b64_tr_b16 v[136:137], v22 offset:0
  ds_read_b64_tr_b16 v[138:139], v22 offset:1152
  s_waitcnt lgkmcnt(9)
  v_mfma_f32_32x32x16_bf16 v[44:59], v[116:119], v[108:111], v[44:59]
  ds_read_b64_tr_b16 v[140:141], v22 offset:32
  ds_read_b64_tr_b16 v[142:143], v22 offset:1184
  s_waitcnt lgkmcnt(9)
  v_mfma_f32_32x32x16_bf16 v[60:75], v[120:123], v[108:111], v[60:75]
  ds_read_b64_tr_b16 v[144:145], v22 offset:64
  s_cmp_gt_u32 s80, 7
  s_cbranch_scc1 ALskip_7
  buffer_load_dwordx4 v12, s[36:39], s73 offen offset:2048 lds
  s_add_u32 m0, s74, s77
  s_nop 0
  buffer_load_dwordx4 v10, s[40:43], s73 offen offset:0 lds
ALskip_7:
  ds_read_b64_tr_b16 v[146:147], v22 offset:1216
  s_waitcnt lgkmcnt(9)
  v_mfma_f32_32x32x16_bf16 v[76:91], v[124:127], v[108:111], v[76:91]
  ds_read_b64_tr_b16 v[148:149], v22 offset:96
  ds_read_b64_tr_b16 v[150:151], v22 offset:1248
  s_waitcnt lgkmcnt(9)
  v_mfma_f32_32x32x16_bf16 v[92:107], v[128:131], v[108:111], v[92:107]
  ds_read_b64_tr_b16 v[152:153], v22 offset:128
  ds_read_b64_tr_b16 v[154:155], v22 offset:1280
  s_waitcnt lgkmcnt(8)
  v_mfma_f32_32x32x16_bf16 v[28:43], v[136:139], v[132:135], v[28:43]
  ds_read_b128 v[108:111], v19
  ds_read_b64_tr_b16 v[112:113], v23 offset:0
  ds_read_b64_tr_b16 v[114:115], v23 offset:1152
  s_waitcnt lgkmcnt(9)
  v_mfma_f32_32x32x16_bf16 v[44:59], v[140:143], v[132:135], v[44:59]
  ds_read_b64_tr_b16 v[116:117], v23 offset:32
  ds_read_b64_tr_b16 v[118:119], v23 offset:1184
  s_waitcnt lgkmcnt(9)
  v_mfma_f32_32x32x16_bf16 v[60:75], v[144:147], v[132:135], v[60:75]
  ds_read_b64_tr_b16 v[120:121], v23 offset:64
  s_cmp_gt_u32 s80, 7
  s_cbranch_scc1 ALskip_8
  buffer_load_dwordx4 v11, s[40:43], s73 offen offset:1024 lds
ALskip_8:
  ds_read_b64_tr_b16 v[122:123], v23 offset:1216
  s_waitcnt lgkmcnt(9)
  v_mfma_f32_32x32x16_bf16 v[76:91], v[148:151], v[132:135], v[76:91]
  ds_read_b64_tr_b16 v[124:125], v23 offset:96
  ds_read_b64_tr_b16 v[126:127], v23 offset:1248
  s_waitcnt lgkmcnt(9)
  v_mfma_f32_32x32x16_bf16 v[92:107], v[152:155], v[132:135], v[92:107]
  ds_read_b64_tr_b16 v[128:129], v23 offset:128
  ds_read_b64_tr_b16 v[130:131], v23 offset:1280
  s_waitcnt lgkmcnt(8)
  v_mfma_f32_32x32x16_bf16 v[28:43], v[112:115], v[108:111], v[28:43]
  ds_read_b128 v[132:135], v20
  ds_read_b64_tr_b16 v[136:137], v24 offset:0
  s_cmp_gt_u32 s80, 7
  s_cbranch_scc1 ALskip_9
  buffer_load_dwordx4 v12, s[40:43], s73 offen offset:2048 lds
ALskip_9:
  s_waitcnt lgkmcnt(8)
  v_mfma_f32_32x32x16_bf16 v[44:59], v[116:119], v[108:111], v[44:59]
  ds_read_b64_tr_b16 v[138:139], v24 offset:1152
  ds_read_b64_tr_b16 v[140:141], v24 offset:32
  ds_read_b64_tr_b16 v[142:143], v24 offset:1184
  s_waitcnt lgkmcnt(9)
  v_mfma_f32_32x32x16_bf16 v[60:75], v[120:123], v[108:111], v[60:75]
  ds_read_b64_tr_b16 v[144:145], v24 offset:64
  s_add_u32 s71, s71, 1
  s_and_b32 s71, s71, 7
  s_lshl_b32 s72, s71, 7
  s_mul_i32 s73, s71, 176128
  s_add_u32 s74, s74, 53376
  s_cmp_ge_u32 s74, 160128
  s_cselect_b32 s74, 0, s74
  s_add_u32 s80, s80, 1
  ds_read_b64_tr_b16 v[146:147], v24 offset:1216
  s_waitcnt lgkmcnt(9)
  v_mfma_f32_32x32x16_bf16 v[76:91], v[124:127], v[108:111], v[76:91]
  ds_read_b64_tr_b16 v[148:149], v24 offset:96
  ds_read_b64_tr_b16 v[150:151], v24 offset:1248
  s_add_u32 s86, s86, 53376
  s_cmp_ge_u32 s86, 160128
  s_cselect_b32 s78, 4294860544, s69
  s_cselect_b32 s86, 0, s86
  s_waitcnt lgkmcnt(9)
  v_mfma_f32_32x32x16_bf16 v[92:107], v[128:131], v[108:111], v[92:107]
  ds_read_b64_tr_b16 v[152:153], v24 offset:128
  ds_read_b64_tr_b16 v[154:155], v24 offset:1280
  s_bitcmp1_b32 18, s75
  s_cbranch_scc1 ALrare_10
  s_waitcnt vmcnt(6) lgkmcnt(0)
ALback_11:
  s_barrier
  v_mfma_f32_32x32x16_bf16 v[28:43], v[136:139], v[132:135], v[28:43]
  v_add_u32 v17, s78, v17
  v_add_u32 v21, s78, v21
  ds_read_b128 v[108:111], v17
  ds_read_b64_tr_b16 v[112:113], v21 offset:0
  v_add_u32 v18, s78, v18
  v_add_u32 v22, s78, v22
  v_mfma_f32_32x32x16_bf16 v[44:59], v[140:143], v[132:135], v[44:59]
  ds_read_b64_tr_b16 v[114:115], v21 offset:1152
  ds_read_b64_tr_b16 v[116:117], v21 offset:32
  ds_read_b64_tr_b16 v[118:119], v21 offset:1184
  v_mfma_f32_32x32x16_bf16 v[60:75], v[144:147], v[132:135], v[60:75]
  ds_read_b64_tr_b16 v[120:121], v21 offset:64
  v_add_u32 v19, s78, v19
  v_add_u32 v23, s78, v23
  s_cmp_gt_u32 s80, 7
  s_cbranch_scc1 ALskip_12
  s_add_u32 m0, s74, s76
  s_nop 0
  buffer_load_dwordx4 v10, s[36:39], s73 offen offset:0 lds
  buffer_load_dwordx4 v11, s[36:39], s73 offen offset:1024 lds
ALskip_12:
  ds_read_b64_tr_b16 v[122:123], v21 offset:1216
  v_mfma_f32_32x32x16_bf16 v[76:91], v[148:151], v[132:135], v[76:91]
  ds_read_b64_tr_b16 v[124:125], v21 offset:96
  ds_read_b64_tr_b16 v[126:127], v21 offset:1248
  v_add_u32 v20, s78, v20
  v_add_u32 v24, s78, v24
  v_mfma_f32_32x32x16_bf16 v[92:107], v[152:155], v[132:135], v[92:107]
  ds_read_b64_tr_b16 v[128:129], v21 offset:128
  ds_read_b64_tr_b16 v[130:131], v21 offset:1280
  s_bitcmp1_b32 41, s75
  s_cbranch_scc1 ALrare_13
ALback_14:
  s_add_u32 s75, s75, 1
  s_add_u32 s92, s92, 1
  s_cmp_lt_u32 s75, 6
  s_cbranch_scc1 parallel_sum__linear_kernel_hedgehog__glu_gated_swiglu__prompt_kernel_f0
  s_add_u32 s68, s79, 4096
  s_cmp_eq_u32 s64, 7
  s_cselect_b32 s81, 0x7ff00000, s79
  ds_read_b128 v[156:159], v18 offset:0
  ds_read_b128 v[160:163], v19 offset:0
  ds_read_b128 v[164:167], v20 offset:0
  ds_read_b64_tr_b16 v[136:137], v22 offset:0
  ds_read_b64_tr_b16 v[138:139], v22 offset:1152
  ds_read_b64_tr_b16 v[140:141], v23 offset:0
  ds_read_b64_tr_b16 v[142:143], v23 offset:1152
  ds_read_b64_tr_b16 v[144:145], v24 offset:0
  ds_read_b64_tr_b16 v[146:147], v24 offset:1152
  s_waitcnt lgkmcnt(15)
  v_mfma_f32_32x32x16_bf16 v[28:43], v[112:115], v[108:111], v[28:43]
  ds_read_b64_tr_b16 v[188:189], v22 offset:32
  ds_read_b64_tr_b16 v[190:191], v22 offset:1184
  s_waitcnt lgkmcnt(6)
  v_mfma_f32_32x32x16_bf16 v[28:43], v[136:139], v[156:159], v[28:43]
  ds_read_b64_tr_b16 v[192:193], v23 offset:32
  s_waitcnt lgkmcnt(5)
  v_mfma_f32_32x32x16_bf16 v[28:43], v[140:143], v[160:163], v[28:43]
  ds_read_b64_tr_b16 v[194:195], v23 offset:1184
  ds_read_b64_tr_b16 v[196:197], v24 offset:32
  s_waitcnt lgkmcnt(5)
  v_mfma_f32_32x32x16_bf16 v[28:43], v[144:147], v[164:167], v[28:43]
  ds_read_b64_tr_b16 v[198:199], v24 offset:1184
  v_mfma_f32_32x32x16_bf16 v[44:59], v[116:119], v[108:111], v[44:59]
  ds_read_b64_tr_b16 v[204:205], v22 offset:64
  ds_read_b64_tr_b16 v[206:207], v22 offset:1216
  s_waitcnt lgkmcnt(6)
  v_mfma_f32_32x32x16_bf16 v[44:59], v[188:191], v[156:159], v[44:59]
  ds_read_b64_tr_b16 v[208:209], v23 offset:64
  s_waitcnt lgkmcnt(5)
  v_mfma_f32_32x32x16_bf16 v[44:59], v[192:195], v[160:163], v[44:59]
  ds_read_b64_tr_b16 v[210:211], v23 offset:1216
  ds_read_b64_tr_b16 v[212:213], v24 offset:64
  s_waitcnt lgkmcnt(5)
  v_mfma_f32_32x32x16_bf16 v[44:59], v[196:199], v[164:167], v[44:59]
  ds_read_b64_tr_b16 v[214:215], v24 offset:1216
  s_waitcnt vmcnt(0) lgkmcnt(0)
  s_barrier
  v_lshlrev_b32 v5, 2, v0
  v_add_u32 v5, 106752, v5
  ds_read_b32 v235, v5 offset:0
  ds_read_b32 v236, v5 offset:256
  ds_read_b32 v237, v5 offset:512
  ds_read_b32 v238, v5 offset:768
  ds_read_b32 v239, v5 offset:1024
  v_and_b32 v4, 31, v0
  v_lshlrev_b32 v4, 3, v4
  s_lshl_b32 s66, s61, 8
  s_add_u32 s66, s66, 109056
  v_add_u32 v4, s66, v4
  ds_read_b64 v[216:217], v4
  v_mfma_f32_32x32x16_bf16 v[60:75], v[120:123], v[108:111], v[60:75]
  ds_read_b128 v[168:171], v17 offset:53376
  ds_read_b128 v[172:175], v18 offset:53376
  ds_read_b128 v[176:179], v19 offset:53376
  ds_read_b128 v[180:183], v20 offset:53376
  v_mfma_f32_32x32x16_bf16 v[60:75], v[204:207], v[156:159], v[60:75]
  ds_read_b64_tr_b16 v[132:133], v21 offset:53376
  ds_read_b64_tr_b16 v[134:135], v21 offset:54528
  ds_read_b64_tr_b16 v[136:137], v22 offset:53376
  v_mfma_f32_32x32x16_bf16 v[60:75], v[208:211], v[160:163], v[60:75]
  ds_read_b64_tr_b16 v[138:139], v22 offset:54528
  ds_read_b64_tr_b16 v[140:141], v23 offset:53376
  ds_read_b64_tr_b16 v[142:143], v23 offset:54528
  v_mfma_f32_32x32x16_bf16 v[60:75], v[212:215], v[164:167], v[60:75]
  ds_read_b64_tr_b16 v[144:145], v24 offset:53376
  ds_read_b64_tr_b16 v[146:147], v24 offset:54528
  s_waitcnt lgkmcnt(12)
  v_rcp_f32 v233, v217
  v_mul_f32 v234, v217, v217
  v_mul_f32 v232, 3216550459, v233
  v_mov_b32 v217, 0
  s_waitcnt lgkmcnt(6)
  v_mfma_f32_32x32x16_bf16 v[28:43], v[132:135], v[168:171], v[28:43]
  ds_read_b64_tr_b16 v[184:185], v21 offset:53408
  ds_read_b64_tr_b16 v[186:187], v21 offset:54560
  s_waitcnt lgkmcnt(6)
  v_mfma_f32_32x32x16_bf16 v[28:43], v[136:139], v[172:175], v[28:43]
  ds_read_b64_tr_b16 v[188:189], v22 offset:53408
  ds_read_b64_tr_b16 v[190:191], v22 offset:54560
  s_waitcnt lgkmcnt(6)
  v_mfma_f32_32x32x16_bf16 v[28:43], v[140:143], v[176:179], v[28:43]
  ds_read_b64_tr_b16 v[192:193], v23 offset:53408
  ds_read_b64_tr_b16 v[194:195], v23 offset:54560
  s_waitcnt lgkmcnt(6)
  v_mfma_f32_32x32x16_bf16 v[28:43], v[144:147], v[180:183], v[28:43]
  ds_read_b64_tr_b16 v[196:197], v24 offset:53408
  ds_read_b64_tr_b16 v[198:199], v24 offset:54560
  v_mov_b32 v220, v235
  s_nop 1
  v_mfma_f32_32x32x16_bf16 v[28:43], v[220:223], v[216:219], v[28:43]
  s_waitcnt lgkmcnt(6)
  v_mfma_f32_32x32x16_bf16 v[44:59], v[184:187], v[168:171], v[44:59]
  ds_read_b64_tr_b16 v[200:201], v21 offset:53440
  ds_read_b64_tr_b16 v[202:203], v21 offset:54592
  ds_read_b64_tr_b16 v[204:205], v22 offset:53440
  ds_read_b64_tr_b16 v[206:207], v22 offset:54592
  s_waitcnt lgkmcnt(8)
  v_mfma_f32_32x32x16_bf16 v[44:59], v[188:191], v[172:175], v[44:59]
  ds_read_b64_tr_b16 v[208:209], v23 offset:53440
  ds_read_b64_tr_b16 v[210:211], v23 offset:54592
  ds_read_b64_tr_b16 v[212:213], v24 offset:53440
  ds_read_b64_tr_b16 v[214:215], v24 offset:54592
  s_waitcnt lgkmcnt(10)
  v_mfma_f32_32x32x16_bf16 v[44:59], v[192:195], v[176:179], v[44:59]
  v_mul_f32 v224, v28, v232
  v_mul_f32 v225, v29, v232
  v_mul_f32 v226, v30, v232
  v_mul_f32 v227, v31, v232
  v_mul_f32 v228, v32, v232
  v_mul_f32 v229, v33, v232
  v_mul_f32 v230, v34, v232
  v_mul_f32 v231, v35, v232
  v_exp_f32 v224, v224
  v_mul_f32 v28, v28, v36
  v_exp_f32 v225, v225
  v_mul_f32 v29, v29, v37
  v_exp_f32 v226, v226
  v_mul_f32 v30, v30, v38
  v_exp_f32 v227, v227
  v_mul_f32 v31, v31, v39
  v_exp_f32 v228, v228
  v_mul_f32 v32, v32, v40
  v_exp_f32 v229, v229
  v_mul_f32 v33, v33, v41
  s_waitcnt lgkmcnt(8)
  v_mfma_f32_32x32x16_bf16 v[44:59], v[196:199], v[180:183], v[44:59]
  v_exp_f32 v230, v230
  v_mul_f32 v34, v34, v42
  v_exp_f32 v231, v231
  v_mul_f32 v35, v35, v43
  v_fma_f32 v224, v224, v234, v234
  v_fma_f32 v225, v225, v234, v234
  v_fma_f32 v226, v226, v234, v234
  v_fma_f32 v227, v227, v234, v234
  v_fma_f32 v228, v228, v234, v234
  v_fma_f32 v229, v229, v234, v234
  v_fma_f32 v230, v230, v234, v234
  v_fma_f32 v231, v231, v234, v234
  v_rcp_f32 v224, v224
  v_rcp_f32 v225, v225
  v_rcp_f32 v226, v226
  v_mul_f32 v28, v28, v224
  v_rcp_f32 v227, v227
  v_mul_f32 v29, v29, v225
  v_rcp_f32 v228, v228
  v_mul_f32 v30, v30, v226
  v_mov_b32 v220, v236
  s_nop 1
  v_mfma_f32_32x32x16_bf16 v[44:59], v[220:223], v[216:219], v[44:59]
  s_waitcnt lgkmcnt(6)
  v_mfma_f32_32x32x16_bf16 v[60:75], v[200:203], v[168:171], v[60:75]
  v_rcp_f32 v229, v229
  v_mul_f32 v31, v31, v227
  v_rcp_f32 v230, v230
  ds_read_b64_tr_b16 v[136:137], v22 offset:96
  v_mul_f32 v32, v32, v228
  v_rcp_f32 v231, v231
  v_mul_f32 v33, v33, v229
  v_mul_f32 v34, v34, v230
  v_mul_f32 v35, v35, v231
  v_cvt_pk_bf16_f32 v28, v28, v29
  v_cvt_pk_bf16_f32 v29, v30, v31
  ds_read_b64_tr_b16 v[138:139], v22 offset:1248
  s_waitcnt lgkmcnt(6)
  v_mfma_f32_32x32x16_bf16 v[60:75], v[204:207], v[172:175], v[60:75]
  v_cvt_pk_bf16_f32 v30, v32, v33
  v_cvt_pk_bf16_f32 v31, v34, v35
  buffer_store_dwordx4 v[28:31], v1, s[28:31], s81 offen offset:0 sc1
  v_mul_f32 v224, v44, v232
  v_mul_f32 v225, v45, v232
  v_mul_f32 v226, v46, v232
  v_mul_f32 v227, v47, v232
  ds_read_b64_tr_b16 v[140:141], v23 offset:96
  v_mul_f32 v228, v48, v232
  v_mul_f32 v229, v49, v232
  v_mul_f32 v230, v50, v232
  s_waitcnt lgkmcnt(5)
  v_mfma_f32_32x32x16_bf16 v[60:75], v[208:211], v[176:179], v[60:75]
  v_mul_f32 v231, v51, v232
  v_exp_f32 v224, v224
  v_mul_f32 v44, v44, v52
  ds_read_b64_tr_b16 v[142:143], v23 offset:1248
  v_exp_f32 v225, v225
  v_mul_f32 v45, v45, v53
  v_exp_f32 v226, v226
  v_mul_f32 v46, v46, v54
  v_exp_f32 v227, v227
  v_mul_f32 v47, v47, v55
  v_exp_f32 v228, v228
  ds_read_b64_tr_b16 v[144:145], v24 offset:96
  s_waitcnt lgkmcnt(5)
  v_mfma_f32_32x32x16_bf16 v[60:75], v[212:215], v[180:183], v[60:75]
  v_mul_f32 v48, v48, v56
  v_exp_f32 v229, v229
  v_mul_f32 v49, v49, v57
  v_exp_f32 v230, v230
  v_mul_f32 v50, v50, v58
  v_exp_f32 v231, v231
  v_mul_f32 v51, v51, v59
  ds_read_b64_tr_b16 v[146:147], v24 offset:1248
  v_fma_f32 v224, v224, v234, v234
  v_fma_f32 v225, v225, v234, v234
  v_fma_f32 v226, v226, v234, v234
  v_mov_b32 v220, v237
  s_nop 1
  v_mfma_f32_32x32x16_bf16 v[60:75], v[220:223], v[216:219], v[60:75]
  v_mfma_f32_32x32x16_bf16 v[76:91], v[124:127], v[108:111], v[76:91]
  v_fma_f32 v227, v227, v234, v234
  v_fma_f32 v228, v228, v234, v234
  ds_read_b64_tr_b16 v[184:185], v21 offset:53472
  v_fma_f32 v229, v229, v234, v234
  v_fma_f32 v230, v230, v234, v234
  v_fma_f32 v231, v231, v234, v234
  v_rcp_f32 v224, v224
  v_rcp_f32 v225, v225
  ds_read_b64_tr_b16 v[186:187], v21 offset:54624
  v_rcp_f32 v226, v226
  v_mul_f32 v44, v44, v224
  v_rcp_f32 v227, v227
  s_waitcnt lgkmcnt(6)
  v_mfma_f32_32x32x16_bf16 v[76:91], v[136:139], v[156:159], v[76:91]
  v_mul_f32 v45, v45, v225
  v_rcp_f32 v228, v228
  ds_read_b64_tr_b16 v[188:189], v22 offset:53472
  v_mul_f32 v46, v46, v226
  v_rcp_f32 v229, v229
  v_mul_f32 v47, v47, v227
  v_rcp_f32 v230, v230
  v_mul_f32 v48, v48, v228
  ds_read_b64_tr_b16 v[190:191], v22 offset:54624
  v_rcp_f32 v231, v231
  v_mul_f32 v49, v49, v229
  v_mul_f32 v50, v50, v230
  s_waitcnt lgkmcnt(6)
  v_mfma_f32_32x32x16_bf16 v[76:91], v[140:143], v[160:163], v[76:91]
  v_mul_f32 v51, v51, v231
  v_cvt_pk_bf16_f32 v44, v44, v45
  ds_read_b64_tr_b16 v[192:193], v23 offset:53472
  v_cvt_pk_bf16_f32 v45, v46, v47
  v_cvt_pk_bf16_f32 v46, v48, v49
  v_cvt_pk_bf16_f32 v47, v50, v51
  buffer_store_dwordx4 v[44:47], v1, s[28:31], s81 offen offset:1024 sc1
  v_mul_f32 v224, v60, v232
  ds_read_b64_tr_b16 v[194:195], v23 offset:54624
  v_mul_f32 v225, v61, v232
  v_mul_f32 v226, v62, v232
  v_mul_f32 v227, v63, v232
  s_waitcnt lgkmcnt(6)
  v_mfma_f32_32x32x16_bf16 v[76:91], v[144:147], v[164:167], v[76:91]
  v_mul_f32 v228, v64, v232
  v_mul_f32 v229, v65, v232
  ds_read_b64_tr_b16 v[196:197], v24 offset:53472
  v_mul_f32 v230, v66, v232
  v_mul_f32 v231, v67, v232
  v_exp_f32 v224, v224
  v_mul_f32 v60, v60, v68
  v_exp_f32 v225, v225
  ds_read_b64_tr_b16 v[198:199], v24 offset:54624
  v_mul_f32 v61, v61, v69
  v_exp_f32 v226, v226
  v_mul_f32 v62, v62, v70
  s_waitcnt lgkmcnt(6)
  v_mfma_f32_32x32x16_bf16 v[76:91], v[184:187], v[168:171], v[76:91]
  v_exp_f32 v227, v227
  v_mul_f32 v63, v63, v71
  v_exp_f32 v228, v228
  ds_read_b64_tr_b16 v[204:205], v22 offset:128
  v_mul_f32 v64, v64, v72
  v_exp_f32 v229, v229
  v_mul_f32 v65, v65, v73
  v_exp_f32 v230, v230
  v_mul_f32 v66, v66, v74
  v_exp_f32 v231, v231
  v_mul_f32 v67, v67, v75
  ds_read_b64_tr_b16 v[206:207], v22 offset:1280
  s_waitcnt lgkmcnt(6)
  v_mfma_f32_32x32x16_bf16 v[76:91], v[188:191], v[172:175], v[76:91]
  v_fma_f32 v224, v224, v234, v234
  v_fma_f32 v225, v225, v234, v234
  v_fma_f32 v226, v226, v234, v234
  v_fma_f32 v227, v227, v234, v234
  v_fma_f32 v228, v228, v234, v234
  v_fma_f32 v229, v229, v234, v234
  ds_read_b64_tr_b16 v[208:209], v23 offset:128
  v_fma_f32 v230, v230, v234, v234
  v_fma_f32 v231, v231, v234, v234
  v_rcp_f32 v224, v224
  v_rcp_f32 v225, v225
  s_waitcnt lgkmcnt(5)
  v_mfma_f32_32x32x16_bf16 v[76:91], v[192:195], v[176:179], v[76:91]
  v_rcp_f32 v226, v226
  v_mul_f32 v60, v60, v224
  v_rcp_f32 v227, v227
  ds_read_b64_tr_b16 v[210:211], v23 offset:1280
  v_mul_f32 v61, v61, v225
  v_rcp_f32 v228, v228
  v_mul_f32 v62, v62, v226
  v_rcp_f32 v229, v229
  v_mul_f32 v63, v63, v227
  v_rcp_f32 v230, v230
  ds_read_b64_tr_b16 v[212:213], v24 offset:128
  s_waitcnt lgkmcnt(5)
  v_mfma_f32_32x32x16_bf16 v[76:91], v[196:199], v[180:183], v[76:91]
  v_mul_f32 v64, v64, v228
  v_rcp_f32 v231, v231
  v_mul_f32 v65, v65, v229
  v_mul_f32 v66, v66, v230
  v_mul_f32 v67, v67, v231
  v_cvt_pk_bf16_f32 v60, v60, v61
  v_cvt_pk_bf16_f32 v61, v62, v63
  ds_read_b64_tr_b16 v[214:215], v24 offset:1280
  v_cvt_pk_bf16_f32 v62, v64, v65
  v_cvt_pk_bf16_f32 v63, v66, v67
  buffer_store_dwordx4 v[60:63], v1, s[28:31], s79 offen offset:2048 sc1
  v_mov_b32 v220, v238
  s_nop 1
  v_mfma_f32_32x32x16_bf16 v[76:91], v[220:223], v[216:219], v[76:91]
  v_mfma_f32_32x32x16_bf16 v[92:107], v[128:131], v[108:111], v[92:107]
  ds_read_b64_tr_b16 v[132:133], v21 offset:53504
  ds_read_b64_tr_b16 v[134:135], v21 offset:54656
  ds_read_b64_tr_b16 v[136:137], v22 offset:53504
  ds_read_b64_tr_b16 v[138:139], v22 offset:54656
  s_waitcnt lgkmcnt(8)
  v_mfma_f32_32x32x16_bf16 v[92:107], v[204:207], v[156:159], v[92:107]
  ds_read_b64_tr_b16 v[140:141], v23 offset:53504
  ds_read_b64_tr_b16 v[142:143], v23 offset:54656
  ds_read_b64_tr_b16 v[144:145], v24 offset:53504
  ds_read_b64_tr_b16 v[146:147], v24 offset:54656
  s_waitcnt lgkmcnt(10)
  v_mfma_f32_32x32x16_bf16 v[92:107], v[208:211], v[160:163], v[92:107]
  v_mul_f32 v224, v76, v232
  v_mul_f32 v225, v77, v232
  v_mul_f32 v226, v78, v232
  v_mul_f32 v227, v79, v232
  v_mul_f32 v228, v80, v232
  v_mul_f32 v229, v81, v232
  v_mul_f32 v230, v82, v232
  v_mul_f32 v231, v83, v232
  v_exp_f32 v224, v224
  v_mul_f32 v76, v76, v84
  v_exp_f32 v225, v225
  v_mul_f32 v77, v77, v85
  v_exp_f32 v226, v226
  v_mul_f32 v78, v78, v86
  v_exp_f32 v227, v227
  v_mul_f32 v79, v79, v87
  v_exp_f32 v228, v228
  v_mul_f32 v80, v80, v88
  v_exp_f32 v229, v229
  v_mul_f32 v81, v81, v89
  s_waitcnt lgkmcnt(8)
  v_mfma_f32_32x32x16_bf16 v[92:107], v[212:215], v[164:167], v[92:107]
  v_exp_f32 v230, v230
  v_mul_f32 v82, v82, v90
  v_exp_f32 v231, v231
  v_mul_f32 v83, v83, v91
  v_fma_f32 v224, v224, v234, v234
  v_fma_f32 v225, v225, v234, v234
  v_fma_f32 v226, v226, v234, v234
  v_fma_f32 v227, v227, v234, v234
  v_fma_f32 v228, v228, v234, v234
  v_fma_f32 v229, v229, v234, v234
  v_fma_f32 v230, v230, v234, v234
  v_fma_f32 v231, v231, v234, v234
  v_rcp_f32 v224, v224
  v_rcp_f32 v225, v225
  v_rcp_f32 v226, v226
  v_mul_f32 v76, v76, v224
  v_rcp_f32 v227, v227
  v_mul_f32 v77, v77, v225
  v_rcp_f32 v228, v228
  v_mul_f32 v78, v78, v226
  s_waitcnt lgkmcnt(6)
  v_mfma_f32_32x32x16_bf16 v[92:107], v[132:135], v[168:171], v[92:107]
  v_rcp_f32 v229, v229
  v_mul_f32 v79, v79, v227
  v_rcp_f32 v230, v230
  v_mul_f32 v80, v80, v228
  s_waitcnt lgkmcnt(4)
  v_mfma_f32_32x32x16_bf16 v[92:107], v[136:139], v[172:175], v[92:107]
  v_rcp_f32 v231, v231
  v_mul_f32 v81, v81, v229
  v_mul_f32 v82, v82, v230
  s_waitcnt lgkmcnt(2)
  v_mfma_f32_32x32x16_bf16 v[92:107], v[140:143], v[176:179], v[92:107]
  v_mul_f32 v83, v83, v231
  v_cvt_pk_bf16_f32 v76, v76, v77
  v_cvt_pk_bf16_f32 v77, v78, v79
  s_waitcnt lgkmcnt(0)
  v_mfma_f32_32x32x16_bf16 v[92:107], v[144:147], v[180:183], v[92:107]
  v_cvt_pk_bf16_f32 v78, v80, v81
  v_cvt_pk_bf16_f32 v79, v82, v83
  buffer_store_dwordx4 v[76:79], v1, s[28:31], s79 offen offset:3072 sc1
  v_mov_b32 v220, v239
  s_nop 1
  v_mfma_f32_32x32x16_bf16 v[92:107], v[220:223], v[216:219], v[92:107]
  s_nop 11
  v_pk_mul_f32 v[224:225], v[92:93], v[232:233] op_sel_hi:[1,0]
  v_pk_mul_f32 v[226:227], v[94:95], v[232:233] op_sel_hi:[1,0]
  v_pk_mul_f32 v[228:229], v[96:97], v[232:233] op_sel_hi:[1,0]
  v_pk_mul_f32 v[230:231], v[98:99], v[232:233] op_sel_hi:[1,0]
  v_exp_f32 v224, v224
  v_exp_f32 v225, v225
  v_exp_f32 v226, v226
  v_exp_f32 v227, v227
  v_exp_f32 v228, v228
  v_exp_f32 v229, v229
  v_exp_f32 v230, v230
  v_exp_f32 v231, v231
  v_pk_mul_f32 v[92:93], v[92:93], v[100:101]
  v_pk_mul_f32 v[94:95], v[94:95], v[102:103]
  v_pk_mul_f32 v[96:97], v[96:97], v[104:105]
  v_pk_mul_f32 v[98:99], v[98:99], v[106:107]
  v_pk_fma_f32 v[224:225], v[224:225], v[234:235], v[234:235] op_sel_hi:[1,0,0]
  v_pk_fma_f32 v[226:227], v[226:227], v[234:235], v[234:235] op_sel_hi:[1,0,0]
  v_pk_fma_f32 v[228:229], v[228:229], v[234:235], v[234:235] op_sel_hi:[1,0,0]
  v_pk_fma_f32 v[230:231], v[230:231], v[234:235], v[234:235] op_sel_hi:[1,0,0]
  v_rcp_f32 v224, v224
  v_rcp_f32 v225, v225
  v_rcp_f32 v226, v226
  v_rcp_f32 v227, v227
  v_rcp_f32 v228, v228
  v_rcp_f32 v229, v229
  v_rcp_f32 v230, v230
  v_rcp_f32 v231, v231
  v_pk_mul_f32 v[92:93], v[92:93], v[224:225]
  v_pk_mul_f32 v[94:95], v[94:95], v[226:227]
  v_pk_mul_f32 v[96:97], v[96:97], v[228:229]
  v_pk_mul_f32 v[98:99], v[98:99], v[230:231]
  v_cvt_pk_bf16_f32 v92, v92, v93
  v_cvt_pk_bf16_f32 v93, v94, v95
  v_cvt_pk_bf16_f32 v94, v96, v97
  v_cvt_pk_bf16_f32 v95, v98, v99
  buffer_store_dwordx4 v[92:95], v1, s[28:31], s68 offen sc1
  s_bfe_u32 s26, s2, 0x30003
  s_mov_b32 s67, s70
  s_lshl_b32 s3, s70, 1
  s_add_u32 s3, s3, s26
  s_and_b32 s27, s2, 1
  s_lshl_b32 s27, s27, 4
  s_and_b32 s66, s2, 6
  s_lshl_b32 s66, s66, 1
  s_add_u32 s27, s27, s66
  s_add_u32 s27, s27, s67
  v_lshrrev_b32 v2, 3, v0
  v_lshlrev_b32 v2, 10, v2
  v_and_b32 v3, 7, v0
  v_bfe_u32 v4, v0, 4, 1
  v_lshlrev_b32 v4, 2, v4
  v_xor_b32 v3, v3, v4
  v_lshl_add_u32 v10, v3, 4, v2
  s_lshl_b32 s66, s26, 7
  v_add_u32 v10, s66, v10
  v_add_u32 v11, 7168, v10
  s_mov_b32 s36, s18
  s_mov_b32 s37, s19
  s_mov_b32 s38, 1409024
  s_mov_b32 s39, 0x20000
  s_waitcnt vmcnt(0)
  s_barrier
  s_cmp_lg_u32 s60, 0
  s_cbranch_scc1 ALskip_33
  s_lshl_b32 s67, s63, 3
  s_add_u32 s67, s67, s64
  s_lshl_b32 s67, s67, 7
  s_add_u32 s67, s67, 15220736
  v_mov_b32 v4, s90
  v_mov_b32 v5, s91
  v_mov_b32 v6, 0
  s_mov_b64 exec, 1
  buffer_store_dwordx2 v[4:5], v6, s[28:31], s67 offen sc1
  s_mov_b64 exec, -1
ALskip_33:
  v_and_b32 v14, 7, v0
  v_lshlrev_b32 v14, 7, v14
  s_lshr_b32 s78, s27, 1
  s_lshl_b32 s78, s78, 10
  s_add_u32 s78, s78, 15220736
  s_mov_b32 s80, 0
  buffer_load_dwordx2 v[12:13], v14, s[28:31], s78 offen sc1
  s_branch parallel_sum__linear_kernel_hedgehog__glu_gated_swiglu__prompt_kernel_ph2
parallel_sum__linear_kernel_hedgehog__glu_gated_swiglu__prompt_kernel_bodyF1:
  s_add_u32 m0, s74, s76
  s_nop 0
  buffer_load_dwordx4 v13, s[32:35], s72 offen offset:0 lds
  buffer_load_dwordx4 v14, s[32:35], s72 offen offset:1024 lds
  buffer_load_dwordx4 v15, s[32:35], s72 offen offset:2048 lds
  buffer_load_dwordx4 v16, s[32:35], s72 offen offset:3072 lds
  s_add_u32 m0, s74, s77
  s_nop 0
  buffer_load_dwordx4 v10, s[44:47], s73 offen offset:0 lds
  buffer_load_dwordx4 v11, s[44:47], s73 offen offset:1024 lds
  buffer_load_dwordx4 v12, s[44:47], s73 offen offset:2048 lds
  s_add_u32 s71, s71, 1
  s_and_b32 s71, s71, 7
  s_lshl_b32 s72, s71, 7
  s_mul_i32 s73, s71, 176128
  s_add_u32 s74, s74, 53376
  s_cmp_ge_u32 s74, 160128
  s_cselect_b32 s74, 0, s74
  s_add_u32 s80, s80, 1
  v_and_b32 v2, 31, v0
  v_lshlrev_b32 v3, 7, v2
  s_lshl_b32 s66, s61, 12
  v_add_u32 v3, s66, v3
  v_bfe_u32 v2, v0, 1, 3
  v_lshrrev_b32 v4, 5, v0
  v_xor_b32 v2, v2, v4
  v_lshl_add_u32 v3, v2, 4, v3
  s_add_u32 s66, s61, 0
  s_and_b32 s66, s66, 3
  s_lshl_b32 s66, s66, 5
  v_xor_b32 v17, s66, v3
  s_add_u32 s66, s61, 1
  s_and_b32 s66, s66, 3
  s_lshl_b32 s66, s66, 5
  v_xor_b32 v18, s66, v3
  s_add_u32 s66, s61, 2
  s_and_b32 s66, s66, 3
  s_lshl_b32 s66, s66, 5
  v_xor_b32 v19, s66, v3
  s_add_u32 s66, s61, 3
  s_and_b32 s66, s66, 3
  s_lshl_b32 s66, s66, 5
  v_xor_b32 v20, s66, v3
  v_bfe_u32 v2, v0, 4, 1
  v_mul_u32_u24 v2, 18560, v2
  v_lshrrev_b32 v3, 5, v0
  v_bfe_u32 v4, v0, 2, 2
  v_lshl_add_u32 v3, v3, 3, v4
  v_mul_u32_u24 v3, 288, v3
  v_add_u32 v2, v2, v3
  v_and_b32 v3, 3, v0
  v_lshl_add_u32 v2, v3, 3, v2
  v_add_u32 v5, 16544, v2
  s_lshl_b32 s66, s60, 5
  s_add_u32 s66, s66, 16384
  v_add_u32 v166, s66, v2
  s_add_u32 s66, s61, 0
  s_and_b32 s66, s66, 3
  s_mul_i32 s66, s66, 4608
  v_add_u32 v21, s66, v5
  s_add_u32 s66, s61, 1
  s_and_b32 s66, s66, 3
  s_mul_i32 s66, s66, 4608
  v_add_u32 v22, s66, v5
  s_add_u32 s66, s61, 2
  s_and_b32 s66, s66, 3
  s_mul_i32 s66, s66, 4608
  v_add_u32 v23, s66, v5
  s_add_u32 s66, s61, 3
  s_and_b32 s66, s66, 3
  s_mul_i32 s66, s66, 4608
  v_add_u32 v24, s66, v5
  v_mov_b64 v[28:29], 0
  v_mov_b64 v[30:31], 0
  v_mov_b64 v[32:33], 0
  v_mov_b64 v[34:35], 0
  v_mov_b64 v[36:37], 0
  v_mov_b64 v[38:39], 0
  v_mov_b64 v[40:41], 0
  v_mov_b64 v[42:43], 0
  v_mov_b64 v[44:45], 0
  v_mov_b64 v[46:47], 0
  v_mov_b64 v[48:49], 0
  v_mov_b64 v[50:51], 0
  v_mov_b64 v[52:53], 0
  v_mov_b64 v[54:55], 0
  v_mov_b64 v[56:57], 0
  v_mov_b64 v[58:59], 0
  v_mov_b64 v[60:61], 0
  v_mov_b64 v[62:63], 0
  v_mov_b64 v[64:65], 0
  v_mov_b64 v[66:67], 0
  v_mov_b64 v[68:69], 0
  v_mov_b64 v[70:71], 0
  v_mov_b64 v[72:73], 0
  v_mov_b64 v[74:75], 0
  v_mov_b64 v[76:77], 0
  v_mov_b64 v[78:79], 0
  v_mov_b64 v[80:81], 0
  v_mov_b64 v[82:83], 0
  v_mov_b64 v[84:85], 0
  v_mov_b64 v[86:87], 0
  v_mov_b64 v[88:89], 0
  v_mov_b64 v[90:91], 0
  v_mov_b32 v184, 0
  v_mov_b32 v185, 0
  v_mov_b32 v186, 0
  v_mov_b32 v187, 0
  v_mov_b32 v201, 0
  v_mov_b32 v202, 0
  v_mov_b32 v203, 0
  v_mov_b32 v205, 0
  v_mov_b32 v206, 0
  v_mov_b32 v207, 0
  s_mov_b32 s28, s24
  s_mov_b32 s29, s25
  s_mov_b32 s30, 16777216
  s_mov_b32 s31, 0x20000
  s_mov_b32 s56, s22
  s_mov_b32 s57, s23
  s_mov_b32 s58, 256
  s_mov_b32 s59, 0x20000
  s_cmp_lg_u32 s60, 6
  s_cbranch_scc1 ALskip_34
  v_lshlrev_b32 v7, 20, v0
  s_mov_b64 exec, 0xffff
  buffer_load_dword v9, v7, s[28:31], 0 offen sc1
  s_mov_b64 exec, 3
  global_load_dword v9, v7, s[20:21]
  global_load_dword v9, v7, s[18:19]
  s_mov_b64 exec, 1
  global_load_dword v9, v7, s[10:11]
  s_mov_b64 exec, -1
ALskip_34:
  s_lshl_b32 s66, s63, 2
  s_add_u32 s66, s66, s61
  s_lshl_b32 s88, s66, 12
  s_add_u32 s88, s88, 14942208
  s_lshl_b32 s92, s60, 8
  s_lshl_b32 s93, s64, 1
  s_lshr_b32 s66, s63, 3
  s_add_u32 s93, s93, s66
  s_lshl_b32 s93, s93, 15
  s_add_u32 s93, s93, 16252928
  s_lshl_b32 s79, s63, 2
  s_add_u32 s79, s79, s61
  s_mul_i32 s79, s79, 118
  s_lshr_b32 s67, s87, 5
  s_add_u32 s79, s79, s67
  s_add_u32 s79, s79, 5
  s_lshl_b32 s79, s79, 10
  s_mov_b32 s75, 0
  s_mov_b32 s86, 0
  s_mov_b32 s69, 53376
  s_lshl_b32 s94, s60, 11
  s_add_u32 s94, s94, s93
  s_waitcnt vmcnt(7)
  s_barrier
  v_mov_b32 v2, 0
  buffer_load_dwordx2 v[164:165], v2, s[56:59], 0 offen offset:128 sc1
  ds_read_b64_tr_b16 v[116:117], v166 offset:0
  ds_read_b64_tr_b16 v[118:119], v166 offset:1152
  ds_read_b64_tr_b16 v[120:121], v166 offset:4608
  ds_read_b64_tr_b16 v[122:123], v166 offset:5760
  ds_read_b64_tr_b16 v[124:125], v166 offset:9216
  ds_read_b64_tr_b16 v[126:127], v166 offset:10368
  ds_read_b64_tr_b16 v[128:129], v166 offset:13824
  ds_read_b64_tr_b16 v[130:131], v166 offset:14976
  ds_read_b128 v[140:143], v17
  ds_read_b128 v[144:147], v18
  ds_read_b128 v[148:151], v19
  ds_read_b128 v[152:155], v20
  s_add_u32 m0, s74, s76
  s_nop 0
  buffer_load_dwordx4 v13, s[32:35], s72 offen offset:0 lds
  buffer_load_dwordx4 v14, s[32:35], s72 offen offset:1024 lds
  s_waitcnt lgkmcnt(11)
  v_lshlrev_b32 v2, 16, v116
  v_and_b32 v3, 0xffff0000, v116
  v_lshlrev_b32 v4, 16, v117
  v_and_b32 v5, 0xffff0000, v117
  v_pk_add_f32 v[6:7], v[2:3], v[4:5]
  s_waitcnt lgkmcnt(10)
  v_lshlrev_b32 v2, 16, v118
  v_and_b32 v3, 0xffff0000, v118
  v_lshlrev_b32 v4, 16, v119
  v_and_b32 v5, 0xffff0000, v119
  v_pk_add_f32 v[6:7], v[6:7], v[2:3]
  v_pk_add_f32 v[6:7], v[6:7], v[4:5]
  s_waitcnt lgkmcnt(9)
  v_lshlrev_b32 v2, 16, v120
  v_and_b32 v3, 0xffff0000, v120
  v_lshlrev_b32 v4, 16, v121
  v_and_b32 v5, 0xffff0000, v121
  v_pk_add_f32 v[6:7], v[6:7], v[2:3]
  v_pk_add_f32 v[6:7], v[6:7], v[4:5]
  s_waitcnt lgkmcnt(8)
  v_lshlrev_b32 v2, 16, v122
  v_and_b32 v3, 0xffff0000, v122
  v_lshlrev_b32 v4, 16, v123
  v_and_b32 v5, 0xffff0000, v123
  v_pk_add_f32 v[6:7], v[6:7], v[2:3]
  v_pk_add_f32 v[6:7], v[6:7], v[4:5]
  s_waitcnt lgkmcnt(7)
  v_lshlrev_b32 v2, 16, v124
  v_and_b32 v3, 0xffff0000, v124
  v_lshlrev_b32 v4, 16, v125
  v_and_b32 v5, 0xffff0000, v125
  v_pk_add_f32 v[6:7], v[6:7], v[2:3]
  v_pk_add_f32 v[6:7], v[6:7], v[4:5]
  s_waitcnt lgkmcnt(6)
  v_lshlrev_b32 v2, 16, v126
  v_and_b32 v3, 0xffff0000, v126
  v_lshlrev_b32 v4, 16, v127
  v_and_b32 v5, 0xffff0000, v127
  v_pk_add_f32 v[6:7], v[6:7], v[2:3]
  v_pk_add_f32 v[6:7], v[6:7], v[4:5]
  s_waitcnt lgkmcnt(5)
  v_lshlrev_b32 v2, 16, v128
  v_and_b32 v3, 0xffff0000, v128
  v_lshlrev_b32 v4, 16, v129
  v_and_b32 v5, 0xffff0000, v129
  v_pk_add_f32 v[6:7], v[6:7], v[2:3]
  v_pk_add_f32 v[6:7], v[6:7], v[4:5]
  s_waitcnt lgkmcnt(4)
  v_lshlrev_b32 v2, 16, v130
  v_and_b32 v3, 0xffff0000, v130
  v_lshlrev_b32 v4, 16, v131
  v_and_b32 v5, 0xffff0000, v131
  v_pk_add_f32 v[6:7], v[6:7], v[2:3]
  v_pk_add_f32 v[6:7], v[6:7], v[4:5]
  v_add_f32 v6, v6, v7
  v_mov_b32 v7, v6
  s_nop 1
  v_permlane32_swap_b32 v6, v7
  v_add_f32 v160, v6, v7
  s_waitcnt lgkmcnt(3)
  v_lshlrev_b32 v2, 16, v140
  v_and_b32 v3, 0xffff0000, v140
  v_lshlrev_b32 v4, 16, v141
  v_and_b32 v5, 0xffff0000, v141
  v_add_f32 v184, v184, v2
  v_add_f32 v185, v185, v3
  v_fmac_f32 v186, v2, v2
  v_fmac_f32 v187, v3, v3
  v_add_f32 v184, v184, v4
  v_add_f32 v185, v185, v5
  v_fmac_f32 v186, v4, v4
  v_fmac_f32 v187, v5, v5
  v_lshlrev_b32 v2, 16, v142
  v_and_b32 v3, 0xffff0000, v142
  v_lshlrev_b32 v4, 16, v143
  v_and_b32 v5, 0xffff0000, v143
  v_add_f32 v184, v184, v2
  v_add_f32 v185, v185, v3
  v_fmac_f32 v186, v2, v2
  v_fmac_f32 v187, v3, v3
  v_add_f32 v184, v184, v4
  v_add_f32 v185, v185, v5
  v_fmac_f32 v186, v4, v4
  v_fmac_f32 v187, v5, v5
  s_waitcnt lgkmcnt(2)
  v_lshlrev_b32 v2, 16, v144
  v_and_b32 v3, 0xffff0000, v144
  v_lshlrev_b32 v4, 16, v145
  v_and_b32 v5, 0xffff0000, v145
  v_add_f32 v184, v184, v2
  v_add_f32 v185, v185, v3
  v_fmac_f32 v186, v2, v2
  v_fmac_f32 v187, v3, v3
  v_add_f32 v184, v184, v4
  v_add_f32 v185, v185, v5
  v_fmac_f32 v186, v4, v4
  v_fmac_f32 v187, v5, v5
  v_lshlrev_b32 v2, 16, v146
  v_and_b32 v3, 0xffff0000, v146
  v_lshlrev_b32 v4, 16, v147
  v_and_b32 v5, 0xffff0000, v147
  v_add_f32 v184, v184, v2
  v_add_f32 v185, v185, v3
  v_fmac_f32 v186, v2, v2
  v_fmac_f32 v187, v3, v3
  v_add_f32 v184, v184, v4
  v_add_f32 v185, v185, v5
  v_fmac_f32 v186, v4, v4
  v_fmac_f32 v187, v5, v5
  s_waitcnt lgkmcnt(1)
  v_lshlrev_b32 v2, 16, v148
  v_and_b32 v3, 0xffff0000, v148
  v_lshlrev_b32 v4, 16, v149
  v_and_b32 v5, 0xffff0000, v149
  v_add_f32 v184, v184, v2
  v_add_f32 v185, v185, v3
  v_fmac_f32 v186, v2, v2
  v_fmac_f32 v187, v3, v3
  v_add_f32 v184, v184, v4
  v_add_f32 v185, v185, v5
  v_fmac_f32 v186, v4, v4
  v_fmac_f32 v187, v5, v5
  v_lshlrev_b32 v2, 16, v150
  v_and_b32 v3, 0xffff0000, v150
  v_lshlrev_b32 v4, 16, v151
  v_and_b32 v5, 0xffff0000, v151
  v_add_f32 v184, v184, v2
  v_add_f32 v185, v185, v3
  v_fmac_f32 v186, v2, v2
  v_fmac_f32 v187, v3, v3
  v_add_f32 v184, v184, v4
  v_add_f32 v185, v185, v5
  v_fmac_f32 v186, v4, v4
  v_fmac_f32 v187, v5, v5
  s_waitcnt lgkmcnt(0)
  v_lshlrev_b32 v2, 16, v152
  v_and_b32 v3, 0xffff0000, v152
  v_lshlrev_b32 v4, 16, v153
  v_and_b32 v5, 0xffff0000, v153
  v_add_f32 v184, v184, v2
  v_add_f32 v185, v185, v3
  v_fmac_f32 v186, v2, v2
  v_fmac_f32 v187, v3, v3
  v_add_f32 v184, v184, v4
  v_add_f32 v185, v185, v5
  v_fmac_f32 v186, v4, v4
  v_fmac_f32 v187, v5, v5
  v_lshlrev_b32 v2, 16, v154
  v_and_b32 v3, 0xffff0000, v154
  v_lshlrev_b32 v4, 16, v155
  v_and_b32 v5, 0xffff0000, v155
  v_add_f32 v184, v184, v2
  v_add_f32 v185, v185, v3
  v_fmac_f32 v186, v2, v2
  v_fmac_f32 v187, v3, v3
  v_add_f32 v184, v184, v4
  v_add_f32 v185, v185, v5
  v_fmac_f32 v186, v4, v4
  v_fmac_f32 v187, v5, v5
  v_add_f32 v184, v184, v185
  v_add_f32 v185, v186, v187
  s_nop 1
  v_permlane32_swap_b32 v184, v185
  v_add_f32 v184, v184, v185
  v_mov_b32 v185, v184
  s_nop 1
  v_permlane32_swap_b32 v184, v185
  v_mov_b32 v156, v184
  v_mov_b32 v158, v185
  ds_read_b128 v[92:95], v17
  ds_read_b64_tr_b16 v[96:97], v21 offset:0
  ds_read_b64_tr_b16 v[98:99], v21 offset:1152
  ds_read_b64_tr_b16 v[100:101], v21 offset:32
  ds_read_b64_tr_b16 v[102:103], v21 offset:1184
  ds_read_b64_tr_b16 v[104:105], v21 offset:64
  ds_read_b64_tr_b16 v[106:107], v21 offset:1216
  ds_read_b64_tr_b16 v[108:109], v21 offset:96
  ds_read_b64_tr_b16 v[110:111], v21 offset:1248
  s_mov_b32 s48, s18
  s_mov_b32 s49, s19
  s_mov_b32 s50, 1409024
  s_mov_b32 s51, 0x20000
  s_lshr_b32 s82, s2, 3
  s_and_b32 s82, s82, 15
  s_mul_i32 s82, s82, 86
  s_add_u32 s82, s82, s60
  s_lshl_b32 s82, s82, 10
parallel_sum__linear_kernel_hedgehog__glu_gated_swiglu__prompt_kernel_f1:
  s_waitcnt lgkmcnt(6)
  v_mfma_f32_32x32x16_bf16 v[28:43], v[96:99], v[92:95], v[28:43]
  ds_read_b128 v[116:119], v18
  ds_read_b64_tr_b16 v[120:121], v22 offset:0
  ds_read_b64_tr_b16 v[122:123], v22 offset:1152
  s_waitcnt lgkmcnt(7)
  v_mfma_f32_32x32x16_bf16 v[44:59], v[100:103], v[92:95], v[44:59]
  ds_read_b64_tr_b16 v[124:125], v22 offset:32
  ds_read_b64_tr_b16 v[126:127], v22 offset:1184
  s_waitcnt lgkmcnt(7)
  v_mfma_f32_32x32x16_bf16 v[60:75], v[104:107], v[92:95], v[60:75]
  s_cmp_gt_u32 s80, 7
  s_cbranch_scc1 ALskip_35
  buffer_load_dwordx4 v15, s[32:35], s72 offen offset:2048 lds
  buffer_load_dwordx4 v16, s[32:35], s72 offen offset:3072 lds
ALskip_35:
  ds_read_b64_tr_b16 v[128:129], v22 offset:64
  ds_read_b64_tr_b16 v[130:131], v22 offset:1216
  s_waitcnt lgkmcnt(7)
  v_mfma_f32_32x32x16_bf16 v[76:91], v[108:111], v[92:95], v[76:91]
  ds_read_b64_tr_b16 v[132:133], v22 offset:96
  ds_read_b64_tr_b16 v[134:135], v22 offset:1248
  s_waitcnt lgkmcnt(6)
  v_mfma_f32_32x32x16_bf16 v[28:43], v[120:123], v[116:119], v[28:43]
  ds_read_b128 v[92:95], v19
  ds_read_b64_tr_b16 v[96:97], v23 offset:0
  ds_read_b64_tr_b16 v[98:99], v23 offset:1152
  s_waitcnt lgkmcnt(7)
  v_mfma_f32_32x32x16_bf16 v[44:59], v[124:127], v[116:119], v[44:59]
  ds_read_b64_tr_b16 v[100:101], v23 offset:32
  ds_read_b64_tr_b16 v[102:103], v23 offset:1184
  s_waitcnt lgkmcnt(7)
  v_mfma_f32_32x32x16_bf16 v[60:75], v[128:131], v[116:119], v[60:75]
  s_cmp_gt_u32 s80, 7
  s_cbranch_scc1 ALskip_36
  s_add_u32 m0, s74, s77
  s_nop 0
  buffer_load_dwordx4 v10, s[44:47], s73 offen offset:0 lds
  buffer_load_dwordx4 v11, s[44:47], s73 offen offset:1024 lds
ALskip_36:
  ds_read_b64_tr_b16 v[104:105], v23 offset:64
  ds_read_b64_tr_b16 v[106:107], v23 offset:1216
  s_waitcnt lgkmcnt(7)
  v_mfma_f32_32x32x16_bf16 v[76:91], v[132:135], v[116:119], v[76:91]
  ds_read_b64_tr_b16 v[108:109], v23 offset:96
  ds_read_b64_tr_b16 v[110:111], v23 offset:1248
  s_waitcnt lgkmcnt(6)
  v_mfma_f32_32x32x16_bf16 v[28:43], v[96:99], v[92:95], v[28:43]
  ds_read_b128 v[116:119], v20
  ds_read_b64_tr_b16 v[120:121], v24 offset:0
  s_cmp_gt_u32 s80, 7
  s_cbranch_scc1 ALskip_37
  buffer_load_dwordx4 v12, s[44:47], s73 offen offset:2048 lds
ALskip_37:
  s_waitcnt lgkmcnt(6)
  v_mfma_f32_32x32x16_bf16 v[44:59], v[100:103], v[92:95], v[44:59]
  ds_read_b64_tr_b16 v[122:123], v24 offset:1152
  ds_read_b64_tr_b16 v[124:125], v24 offset:32
  ds_read_b64_tr_b16 v[126:127], v24 offset:1184
  s_waitcnt lgkmcnt(7)
  v_mfma_f32_32x32x16_bf16 v[60:75], v[104:107], v[92:95], v[60:75]
  s_add_u32 s71, s71, 1
  s_and_b32 s71, s71, 7
  s_lshl_b32 s72, s71, 7
  s_mul_i32 s73, s71, 176128
  s_add_u32 s74, s74, 53376
  s_cmp_ge_u32 s74, 160128
  s_cselect_b32 s74, 0, s74
  s_add_u32 s80, s80, 1
  ds_read_b64_tr_b16 v[128:129], v24 offset:64
  ds_read_b64_tr_b16 v[130:131], v24 offset:1216
  s_waitcnt lgkmcnt(7)
  v_mfma_f32_32x32x16_bf16 v[76:91], v[108:111], v[92:95], v[76:91]
  ds_read_b64_tr_b16 v[132:133], v24 offset:96
  s_add_u32 s86, s86, 53376
  s_cmp_ge_u32 s86, 160128
  s_cselect_b32 s78, 4294860544, s69
  s_cselect_b32 s86, 0, s86
  ds_read_b64_tr_b16 v[134:135], v24 offset:1248
  s_bitcmp1_b32 18, s75
  s_cbranch_scc1 ALrare_38
  s_waitcnt vmcnt(7) lgkmcnt(0)
ALback_39:
  s_barrier
  v_mfma_f32_32x32x16_bf16 v[28:43], v[120:123], v[116:119], v[28:43]
  v_add_u32 v17, s78, v17
  v_add_u32 v21, s78, v21
  ds_read_b128 v[92:95], v17
  ds_read_b64_tr_b16 v[96:97], v21 offset:0
  v_add_u32 v18, s78, v18
  v_add_u32 v22, s78, v22
  v_mfma_f32_32x32x16_bf16 v[44:59], v[124:127], v[116:119], v[44:59]
  ds_read_b64_tr_b16 v[98:99], v21 offset:1152
  ds_read_b64_tr_b16 v[100:101], v21 offset:32
  ds_read_b64_tr_b16 v[102:103], v21 offset:1184
  v_add_u32 v19, s78, v19
  v_add_u32 v23, s78, v23
  v_mfma_f32_32x32x16_bf16 v[60:75], v[128:131], v[116:119], v[60:75]
  s_cmp_gt_u32 s80, 7
  s_cbranch_scc1 ALskip_40
  s_add_u32 m0, s74, s76
  s_nop 0
  buffer_load_dwordx4 v13, s[32:35], s72 offen offset:0 lds
  buffer_load_dwordx4 v14, s[32:35], s72 offen offset:1024 lds
ALskip_40:
  ds_read_b64_tr_b16 v[104:105], v21 offset:64
  ds_read_b64_tr_b16 v[106:107], v21 offset:1216
  ds_read_b64_tr_b16 v[108:109], v21 offset:96
  v_mfma_f32_32x32x16_bf16 v[76:91], v[132:135], v[116:119], v[76:91]
  v_add_u32 v20, s78, v20
  v_add_u32 v24, s78, v24
  ds_read_b64_tr_b16 v[110:111], v21 offset:1248
  s_bitcmp1_b32 41, s75
  s_cbranch_scc1 ALrare_41
ALback_42:
  s_add_u32 s75, s75, 1
  s_add_u32 s92, s92, 1
  s_cmp_lt_u32 s75, 6
  s_cbranch_scc1 parallel_sum__linear_kernel_hedgehog__glu_gated_swiglu__prompt_kernel_f1
  s_add_u32 s68, s79, 4096
  s_cmp_eq_u32 s64, 7
  s_cselect_b32 s81, 0x7ff00000, s79
  ds_read_b128 v[140:143], v18 offset:0
  ds_read_b128 v[144:147], v19 offset:0
  ds_read_b128 v[148:151], v20 offset:0
  ds_read_b64_tr_b16 v[120:121], v22 offset:0
  ds_read_b64_tr_b16 v[122:123], v22 offset:1152
  ds_read_b64_tr_b16 v[124:125], v23 offset:0
  ds_read_b64_tr_b16 v[126:127], v23 offset:1152
  ds_read_b64_tr_b16 v[128:129], v24 offset:0
  ds_read_b64_tr_b16 v[130:131], v24 offset:1152
  s_waitcnt lgkmcnt(15)
  v_mfma_f32_32x32x16_bf16 v[28:43], v[96:99], v[92:95], v[28:43]
  ds_read_b64_tr_b16 v[172:173], v22 offset:32
  ds_read_b64_tr_b16 v[174:175], v22 offset:1184
  s_waitcnt lgkmcnt(6)
  v_mfma_f32_32x32x16_bf16 v[28:43], v[120:123], v[140:143], v[28:43]
  ds_read_b64_tr_b16 v[176:177], v23 offset:32
  s_waitcnt lgkmcnt(5)
  v_mfma_f32_32x32x16_bf16 v[28:43], v[124:127], v[144:147], v[28:43]
  ds_read_b64_tr_b16 v[178:179], v23 offset:1184
  ds_read_b64_tr_b16 v[180:181], v24 offset:32
  s_waitcnt lgkmcnt(5)
  v_mfma_f32_32x32x16_bf16 v[28:43], v[128:131], v[148:151], v[28:43]
  ds_read_b64_tr_b16 v[182:183], v24 offset:1184
  v_mfma_f32_32x32x16_bf16 v[44:59], v[100:103], v[92:95], v[44:59]
  ds_read_b64_tr_b16 v[188:189], v22 offset:64
  ds_read_b64_tr_b16 v[190:191], v22 offset:1216
  s_waitcnt lgkmcnt(6)
  v_mfma_f32_32x32x16_bf16 v[44:59], v[172:175], v[140:143], v[44:59]
  ds_read_b64_tr_b16 v[192:193], v23 offset:64
  s_waitcnt lgkmcnt(5)
  v_mfma_f32_32x32x16_bf16 v[44:59], v[176:179], v[144:147], v[44:59]
  ds_read_b64_tr_b16 v[194:195], v23 offset:1216
  ds_read_b64_tr_b16 v[196:197], v24 offset:64
  s_waitcnt lgkmcnt(5)
  v_mfma_f32_32x32x16_bf16 v[44:59], v[180:183], v[148:151], v[44:59]
  ds_read_b64_tr_b16 v[198:199], v24 offset:1216
  s_waitcnt vmcnt(0) lgkmcnt(0)
  s_barrier
  v_lshlrev_b32 v5, 2, v0
  v_add_u32 v5, 108032, v5
  ds_read_b32 v219, v5 offset:0
  ds_read_b32 v220, v5 offset:256
  ds_read_b32 v221, v5 offset:512
  ds_read_b32 v222, v5 offset:768
  v_mfma_f32_32x32x16_bf16 v[60:75], v[104:107], v[92:95], v[60:75]
  ds_read_b128 v[152:155], v17 offset:53376
  ds_read_b128 v[156:159], v18 offset:53376
  ds_read_b128 v[160:163], v19 offset:53376
  ds_read_b128 v[164:167], v20 offset:53376
  v_mfma_f32_32x32x16_bf16 v[60:75], v[188:191], v[140:143], v[60:75]
  ds_read_b64_tr_b16 v[116:117], v21 offset:53376
  ds_read_b64_tr_b16 v[118:119], v21 offset:54528
  ds_read_b64_tr_b16 v[120:121], v22 offset:53376
  v_mfma_f32_32x32x16_bf16 v[60:75], v[192:195], v[144:147], v[60:75]
  ds_read_b64_tr_b16 v[122:123], v22 offset:54528
  ds_read_b64_tr_b16 v[124:125], v23 offset:53376
  ds_read_b64_tr_b16 v[126:127], v23 offset:54528
  v_mfma_f32_32x32x16_bf16 v[60:75], v[196:199], v[148:151], v[60:75]
  ds_read_b64_tr_b16 v[128:129], v24 offset:53376
  ds_read_b64_tr_b16 v[130:131], v24 offset:54528
  v_rcp_f32 v217, v201
  v_mul_f32 v218, v201, v201
  v_mul_f32 v216, 3216550459, v217
  v_mov_b32 v201, 0
  s_waitcnt lgkmcnt(6)
  v_mfma_f32_32x32x16_bf16 v[28:43], v[116:119], v[152:155], v[28:43]
  ds_read_b64_tr_b16 v[168:169], v21 offset:53408
  ds_read_b64_tr_b16 v[170:171], v21 offset:54560
  s_waitcnt lgkmcnt(6)
  v_mfma_f32_32x32x16_bf16 v[28:43], v[120:123], v[156:159], v[28:43]
  ds_read_b64_tr_b16 v[172:173], v22 offset:53408
  ds_read_b64_tr_b16 v[174:175], v22 offset:54560
  s_waitcnt lgkmcnt(6)
  v_mfma_f32_32x32x16_bf16 v[28:43], v[124:127], v[160:163], v[28:43]
  ds_read_b64_tr_b16 v[176:177], v23 offset:53408
  ds_read_b64_tr_b16 v[178:179], v23 offset:54560
  s_waitcnt lgkmcnt(6)
  v_mfma_f32_32x32x16_bf16 v[28:43], v[128:131], v[164:167], v[28:43]
  ds_read_b64_tr_b16 v[180:181], v24 offset:53408
  ds_read_b64_tr_b16 v[182:183], v24 offset:54560
  v_mov_b32 v204, v219
  s_nop 1
  v_mfma_f32_32x32x16_bf16 v[28:43], v[204:207], v[200:203], v[28:43]
  s_waitcnt lgkmcnt(6)
  v_mfma_f32_32x32x16_bf16 v[44:59], v[168:171], v[152:155], v[44:59]
  ds_read_b64_tr_b16 v[184:185], v21 offset:53440
  ds_read_b64_tr_b16 v[186:187], v21 offset:54592
  ds_read_b64_tr_b16 v[188:189], v22 offset:53440
  ds_read_b64_tr_b16 v[190:191], v22 offset:54592
  s_waitcnt lgkmcnt(8)
  v_mfma_f32_32x32x16_bf16 v[44:59], v[172:175], v[156:159], v[44:59]
  ds_read_b64_tr_b16 v[192:193], v23 offset:53440
  ds_read_b64_tr_b16 v[194:195], v23 offset:54592
  ds_read_b64_tr_b16 v[196:197], v24 offset:53440
  ds_read_b64_tr_b16 v[198:199], v24 offset:54592
  s_waitcnt lgkmcnt(10)
  v_mfma_f32_32x32x16_bf16 v[44:59], v[176:179], v[160:163], v[44:59]
  v_mul_f32 v208, v28, v216
  v_mul_f32 v209, v29, v216
  v_mul_f32 v210, v30, v216
  v_mul_f32 v211, v31, v216
  v_mul_f32 v212, v32, v216
  v_mul_f32 v213, v33, v216
  v_mul_f32 v214, v34, v216
  v_mul_f32 v215, v35, v216
  v_exp_f32 v208, v208
  v_mul_f32 v28, v28, v36
  v_exp_f32 v209, v209
  v_mul_f32 v29, v29, v37
  v_exp_f32 v210, v210
  v_mul_f32 v30, v30, v38
  v_exp_f32 v211, v211
  v_mul_f32 v31, v31, v39
  v_exp_f32 v212, v212
  v_mul_f32 v32, v32, v40
  v_exp_f32 v213, v213
  v_mul_f32 v33, v33, v41
  s_waitcnt lgkmcnt(8)
  v_mfma_f32_32x32x16_bf16 v[44:59], v[180:183], v[164:167], v[44:59]
  v_exp_f32 v214, v214
  v_mul_f32 v34, v34, v42
  v_exp_f32 v215, v215
  v_mul_f32 v35, v35, v43
  v_fma_f32 v208, v208, v218, v218
  v_fma_f32 v209, v209, v218, v218
  v_fma_f32 v210, v210, v218, v218
  v_fma_f32 v211, v211, v218, v218
  v_fma_f32 v212, v212, v218, v218
  v_fma_f32 v213, v213, v218, v218
  v_fma_f32 v214, v214, v218, v218
  v_fma_f32 v215, v215, v218, v218
  v_rcp_f32 v208, v208
  v_rcp_f32 v209, v209
  v_rcp_f32 v210, v210
  v_mul_f32 v28, v28, v208
  v_rcp_f32 v211, v211
  v_mul_f32 v29, v29, v209
  v_rcp_f32 v212, v212
  v_mul_f32 v30, v30, v210
  v_mov_b32 v204, v220
  s_nop 1
  v_mfma_f32_32x32x16_bf16 v[44:59], v[204:207], v[200:203], v[44:59]
  s_waitcnt lgkmcnt(6)
  v_mfma_f32_32x32x16_bf16 v[60:75], v[184:187], v[152:155], v[60:75]
  v_rcp_f32 v213, v213
  v_mul_f32 v31, v31, v211
  v_rcp_f32 v214, v214
  ds_read_b64_tr_b16 v[120:121], v22 offset:96
  v_mul_f32 v32, v32, v212
  v_rcp_f32 v215, v215
  v_mul_f32 v33, v33, v213
  v_mul_f32 v34, v34, v214
  v_mul_f32 v35, v35, v215
  v_cvt_pk_bf16_f32 v28, v28, v29
  v_cvt_pk_bf16_f32 v29, v30, v31
  ds_read_b64_tr_b16 v[122:123], v22 offset:1248
  s_waitcnt lgkmcnt(6)
  v_mfma_f32_32x32x16_bf16 v[60:75], v[188:191], v[156:159], v[60:75]
  v_cvt_pk_bf16_f32 v30, v32, v33
  v_cvt_pk_bf16_f32 v31, v34, v35
  buffer_store_dwordx4 v[28:31], v1, s[28:31], s79 offen offset:0 sc1
  v_mul_f32 v208, v44, v216
  v_mul_f32 v209, v45, v216
  v_mul_f32 v210, v46, v216
  v_mul_f32 v211, v47, v216
  ds_read_b64_tr_b16 v[124:125], v23 offset:96
  v_mul_f32 v212, v48, v216
  v_mul_f32 v213, v49, v216
  v_mul_f32 v214, v50, v216
  s_waitcnt lgkmcnt(5)
  v_mfma_f32_32x32x16_bf16 v[60:75], v[192:195], v[160:163], v[60:75]
  v_mul_f32 v215, v51, v216
  v_exp_f32 v208, v208
  v_mul_f32 v44, v44, v52
  ds_read_b64_tr_b16 v[126:127], v23 offset:1248
  v_exp_f32 v209, v209
  v_mul_f32 v45, v45, v53
  v_exp_f32 v210, v210
  v_mul_f32 v46, v46, v54
  v_exp_f32 v211, v211
  v_mul_f32 v47, v47, v55
  v_exp_f32 v212, v212
  ds_read_b64_tr_b16 v[128:129], v24 offset:96
  s_waitcnt lgkmcnt(5)
  v_mfma_f32_32x32x16_bf16 v[60:75], v[196:199], v[164:167], v[60:75]
  v_mul_f32 v48, v48, v56
  v_exp_f32 v213, v213
  v_mul_f32 v49, v49, v57
  v_exp_f32 v214, v214
  v_mul_f32 v50, v50, v58
  v_exp_f32 v215, v215
  v_mul_f32 v51, v51, v59
  ds_read_b64_tr_b16 v[130:131], v24 offset:1248
  v_fma_f32 v208, v208, v218, v218
  v_fma_f32 v209, v209, v218, v218
  v_fma_f32 v210, v210, v218, v218
  v_mov_b32 v204, v221
  s_nop 1
  v_mfma_f32_32x32x16_bf16 v[60:75], v[204:207], v[200:203], v[60:75]
  v_mfma_f32_32x32x16_bf16 v[76:91], v[108:111], v[92:95], v[76:91]
  v_fma_f32 v211, v211, v218, v218
  v_fma_f32 v212, v212, v218, v218
  ds_read_b64_tr_b16 v[168:169], v21 offset:53472
  v_fma_f32 v213, v213, v218, v218
  v_fma_f32 v214, v214, v218, v218
  v_fma_f32 v215, v215, v218, v218
  v_rcp_f32 v208, v208
  v_rcp_f32 v209, v209
  ds_read_b64_tr_b16 v[170:171], v21 offset:54624
  v_rcp_f32 v210, v210
  v_mul_f32 v44, v44, v208
  v_rcp_f32 v211, v211
  s_waitcnt lgkmcnt(6)
  v_mfma_f32_32x32x16_bf16 v[76:91], v[120:123], v[140:143], v[76:91]
  v_mul_f32 v45, v45, v209
  v_rcp_f32 v212, v212
  ds_read_b64_tr_b16 v[172:173], v22 offset:53472
  v_mul_f32 v46, v46, v210
  v_rcp_f32 v213, v213
  v_mul_f32 v47, v47, v211
  v_rcp_f32 v214, v214
  v_mul_f32 v48, v48, v212
  ds_read_b64_tr_b16 v[174:175], v22 offset:54624
  v_rcp_f32 v215, v215
  v_mul_f32 v49, v49, v213
  v_mul_f32 v50, v50, v214
  s_waitcnt lgkmcnt(6)
  v_mfma_f32_32x32x16_bf16 v[76:91], v[124:127], v[144:147], v[76:91]
  v_mul_f32 v51, v51, v215
  v_cvt_pk_bf16_f32 v44, v44, v45
  ds_read_b64_tr_b16 v[176:177], v23 offset:53472
  v_cvt_pk_bf16_f32 v45, v46, v47
  v_cvt_pk_bf16_f32 v46, v48, v49
  v_cvt_pk_bf16_f32 v47, v50, v51
  buffer_store_dwordx4 v[44:47], v1, s[28:31], s79 offen offset:1024 sc1
  v_mul_f32 v208, v60, v216
  ds_read_b64_tr_b16 v[178:179], v23 offset:54624
  v_mul_f32 v209, v61, v216
  v_mul_f32 v210, v62, v216
  v_mul_f32 v211, v63, v216
  s_waitcnt lgkmcnt(6)
  v_mfma_f32_32x32x16_bf16 v[76:91], v[128:131], v[148:151], v[76:91]
  v_mul_f32 v212, v64, v216
  v_mul_f32 v213, v65, v216
  ds_read_b64_tr_b16 v[180:181], v24 offset:53472
  v_mul_f32 v214, v66, v216
  v_mul_f32 v215, v67, v216
  v_exp_f32 v208, v208
  v_mul_f32 v60, v60, v68
  v_exp_f32 v209, v209
  ds_read_b64_tr_b16 v[182:183], v24 offset:54624
  v_mul_f32 v61, v61, v69
  v_exp_f32 v210, v210
  v_mul_f32 v62, v62, v70
  s_waitcnt lgkmcnt(6)
  v_mfma_f32_32x32x16_bf16 v[76:91], v[168:171], v[152:155], v[76:91]
  v_exp_f32 v211, v211
  v_mul_f32 v63, v63, v71
  v_exp_f32 v212, v212
  v_mul_f32 v64, v64, v72
  v_exp_f32 v213, v213
  v_mul_f32 v65, v65, v73
  v_exp_f32 v214, v214
  v_mul_f32 v66, v66, v74
  v_exp_f32 v215, v215
  v_mul_f32 v67, v67, v75
  s_waitcnt lgkmcnt(4)
  v_mfma_f32_32x32x16_bf16 v[76:91], v[172:175], v[156:159], v[76:91]
  v_fma_f32 v208, v208, v218, v218
  v_fma_f32 v209, v209, v218, v218
  v_fma_f32 v210, v210, v218, v218
  v_fma_f32 v211, v211, v218, v218
  v_fma_f32 v212, v212, v218, v218
  v_fma_f32 v213, v213, v218, v218
  v_fma_f32 v214, v214, v218, v218
  v_fma_f32 v215, v215, v218, v218
  v_rcp_f32 v208, v208
  v_rcp_f32 v209, v209
  s_waitcnt lgkmcnt(2)
  v_mfma_f32_32x32x16_bf16 v[76:91], v[176:179], v[160:163], v[76:91]
  v_rcp_f32 v210, v210
  v_mul_f32 v60, v60, v208
  v_rcp_f32 v211, v211
  v_mul_f32 v61, v61, v209
  v_rcp_f32 v212, v212
  v_mul_f32 v62, v62, v210
  v_rcp_f32 v213, v213
  v_mul_f32 v63, v63, v211
  v_rcp_f32 v214, v214
  v_mul_f32 v64, v64, v212
  s_waitcnt lgkmcnt(0)
  v_mfma_f32_32x32x16_bf16 v[76:91], v[180:183], v[164:167], v[76:91]
  v_rcp_f32 v215, v215
  v_mul_f32 v65, v65, v213
  v_mul_f32 v66, v66, v214
  v_mul_f32 v67, v67, v215
  v_cvt_pk_bf16_f32 v60, v60, v61
  v_cvt_pk_bf16_f32 v61, v62, v63
  v_cvt_pk_bf16_f32 v62, v64, v65
  v_cvt_pk_bf16_f32 v63, v66, v67
  buffer_store_dwordx4 v[60:63], v1, s[28:31], s79 offen offset:2048 sc1
  v_mov_b32 v204, v222
  s_nop 1
  v_mfma_f32_32x32x16_bf16 v[76:91], v[204:207], v[200:203], v[76:91]
  s_nop 11
  v_pk_mul_f32 v[208:209], v[76:77], v[216:217] op_sel_hi:[1,0]
  v_pk_mul_f32 v[210:211], v[78:79], v[216:217] op_sel_hi:[1,0]
  v_pk_mul_f32 v[212:213], v[80:81], v[216:217] op_sel_hi:[1,0]
  v_pk_mul_f32 v[214:215], v[82:83], v[216:217] op_sel_hi:[1,0]
  v_exp_f32 v208, v208
  v_exp_f32 v209, v209
  v_exp_f32 v210, v210
  v_exp_f32 v211, v211
  v_exp_f32 v212, v212
  v_exp_f32 v213, v213
  v_exp_f32 v214, v214
  v_exp_f32 v215, v215
  v_pk_mul_f32 v[76:77], v[76:77], v[84:85]
  v_pk_mul_f32 v[78:79], v[78:79], v[86:87]
  v_pk_mul_f32 v[80:81], v[80:81], v[88:89]
  v_pk_mul_f32 v[82:83], v[82:83], v[90:91]
  v_pk_fma_f32 v[208:209], v[208:209], v[218:219], v[218:219] op_sel_hi:[1,0,0]
  v_pk_fma_f32 v[210:211], v[210:211], v[218:219], v[218:219] op_sel_hi:[1,0,0]
  v_pk_fma_f32 v[212:213], v[212:213], v[218:219], v[218:219] op_sel_hi:[1,0,0]
  v_pk_fma_f32 v[214:215], v[214:215], v[218:219], v[218:219] op_sel_hi:[1,0,0]
  v_rcp_f32 v208, v208
  v_rcp_f32 v209, v209
  v_rcp_f32 v210, v210
  v_rcp_f32 v211, v211
  v_rcp_f32 v212, v212
  v_rcp_f32 v213, v213
  v_rcp_f32 v214, v214
  v_rcp_f32 v215, v215
  v_pk_mul_f32 v[76:77], v[76:77], v[208:209]
  v_pk_mul_f32 v[78:79], v[78:79], v[210:211]
  v_pk_mul_f32 v[80:81], v[80:81], v[212:213]
  v_pk_mul_f32 v[82:83], v[82:83], v[214:215]
  v_cvt_pk_bf16_f32 v76, v76, v77
  v_cvt_pk_bf16_f32 v77, v78, v79
  v_cvt_pk_bf16_f32 v78, v80, v81
  v_cvt_pk_bf16_f32 v79, v82, v83
  buffer_store_dwordx4 v[76:79], v1, s[28:31], s79 offen offset:3072 sc1
  s_bfe_u32 s26, s2, 0x30003
  s_mov_b32 s67, s70
  s_lshl_b32 s3, s70, 1
  s_add_u32 s3, s3, s26
  s_and_b32 s27, s2, 1
  s_lshl_b32 s27, s27, 4
  s_and_b32 s66, s2, 6
  s_lshl_b32 s66, s66, 1
  s_add_u32 s27, s27, s66
  s_add_u32 s27, s27, s67
  v_lshrrev_b32 v2, 3, v0
  v_lshlrev_b32 v2, 10, v2
  v_and_b32 v3, 7, v0
  v_bfe_u32 v4, v0, 4, 1
  v_lshlrev_b32 v4, 2, v4
  v_xor_b32 v3, v3, v4
  v_lshl_add_u32 v10, v3, 4, v2
  s_lshl_b32 s66, s26, 7
  v_add_u32 v10, s66, v10
  v_add_u32 v11, 7168, v10
  s_mov_b32 s36, s18
  s_mov_b32 s37, s19
  s_mov_b32 s38, 1409024
  s_mov_b32 s39, 0x20000
  s_waitcnt vmcnt(0)
  s_barrier
  s_cmp_lg_u32 s60, 0
  s_cbranch_scc1 ALskip_54
  s_lshl_b32 s67, s63, 3
  s_add_u32 s67, s67, s64
  s_lshl_b32 s67, s67, 7
  s_add_u32 s67, s67, 15220736
  v_mov_b32 v4, s90
  v_mov_b32 v5, s91
  v_mov_b32 v6, 0
  s_mov_b64 exec, 1
  buffer_store_dwordx2 v[4:5], v6, s[28:31], s67 offen sc1
  s_mov_b64 exec, -1
ALskip_54:
  v_and_b32 v14, 7, v0
  v_lshlrev_b32 v14, 7, v14
  s_lshr_b32 s78, s27, 1
  s_lshl_b32 s78, s78, 10
  s_add_u32 s78, s78, 15220736
  s_mov_b32 s80, 0
  buffer_load_dwordx2 v[12:13], v14, s[28:31], s78 offen sc1
  s_branch parallel_sum__linear_kernel_hedgehog__glu_gated_swiglu__prompt_kernel_ph2
parallel_sum__linear_kernel_hedgehog__glu_gated_swiglu__prompt_kernel_bodyA:
  s_mov_b32 s28, s24
  s_mov_b32 s29, s25
  s_mov_b32 s30, 16777216
  s_mov_b32 s31, 0x20000
  s_mov_b32 s56, s22
  s_mov_b32 s57, s23
  s_mov_b32 s58, 256
  s_mov_b32 s59, 0x20000
  s_cmp_lg_u32 s60, 6
  s_cbranch_scc1 ALskip_55
  v_lshlrev_b32 v7, 20, v0
  s_mov_b64 exec, 0xffff
  buffer_load_dword v9, v7, s[28:31], 0 offen sc1
  s_mov_b64 exec, 3
  global_load_dword v9, v7, s[20:21]
  global_load_dword v9, v7, s[18:19]
  s_mov_b64 exec, 1
  global_load_dword v9, v7, s[10:11]
  s_mov_b64 exec, -1
ALskip_55:
  s_lshl_b32 s66, s63, 2
  s_add_u32 s66, s66, s61
  s_lshl_b32 s88, s66, 12
  s_add_u32 s88, s88, 14680064
  s_lshl_b32 s92, s60, 8
  s_lshl_b32 s93, s64, 1
  s_lshr_b32 s66, s63, 3
  s_add_u32 s93, s93, s66
  s_lshl_b32 s93, s93, 15
  s_add_u32 s93, s93, 15728640
  s_add_u32 s71, s65, 1
  s_and_b32 s71, s71, 7
  s_lshl_b32 s72, s71, 7
  s_add_u32 m0, s76, 32768
  s_mul_i32 s73, s71, 196608
  buffer_load_dwordx4 v10, s[32:35], s72 offen lds
  buffer_load_dwordx4 v11, s[32:35], s72 offen offset:1024 lds
  s_add_u32 m0, s77, 48128
  s_add_u32 s85, s73, 2048
  buffer_load_dwordx4 v12, s[48:51], s73 offen offset:1024 lds
  s_add_u32 m0, s77, 57344
  s_nop 0
  buffer_load_dwordx4 v12, s[48:51], s85 offen lds
  v_lshrrev_b32 v2, 2, v0
  s_lshl_b32 s66, s61, 4
  v_add_u32 v2, s66, v2
  v_mul_u32_u24 v2, 2752, v2
  v_and_b32 v3, 3, v0
  s_lshl_b32 s66, s62, 1
  v_xor_b32 v3, s66, v3
  v_lshl_add_u32 v2, v3, 4, v2
  s_lshl_b32 s66, s64, 6
  v_add_u32 v13, s66, v2
  s_cmp_eq_u32 s62, 0
  s_cselect_b64 s[44:45], s[14:15], s[16:17]
  s_mov_b32 s46, 1409024
  s_mov_b32 s47, 0x20000
  s_mov_b32 s52, s8
  s_mov_b32 s53, s9
  s_mov_b32 s54, 16384
  s_mov_b32 s55, 0x20000
  v_and_b32 v2, 31, v0
  v_lshlrev_b32 v3, 7, v2
  s_lshl_b32 s66, s61, 12
  v_add_u32 v3, s66, v3
  v_bfe_u32 v2, v0, 1, 3
  v_lshrrev_b32 v4, 5, v0
  v_xor_b32 v2, v2, v4
  v_lshl_add_u32 v3, v2, 4, v3
  s_add_u32 s66, s61, 0
  s_and_b32 s66, s66, 3
  s_lshl_b32 s66, s66, 5
  v_xor_b32 v14, s66, v3
  s_add_u32 s66, s61, 1
  s_and_b32 s66, s66, 3
  s_lshl_b32 s66, s66, 5
  v_xor_b32 v15, s66, v3
  s_add_u32 s66, s61, 2
  s_and_b32 s66, s66, 3
  s_lshl_b32 s66, s66, 5
  v_xor_b32 v16, s66, v3
  s_add_u32 s66, s61, 3
  s_and_b32 s66, s66, 3
  s_lshl_b32 s66, s66, 5
  v_xor_b32 v17, s66, v3
  v_lshrrev_b32 v2, 5, v0
  v_bfe_u32 v3, v0, 2, 2
  v_lshl_add_u32 v2, v2, 3, v3
  v_bfe_u32 v3, v0, 4, 1
  v_bfe_u32 v4, v0, 1, 1
  v_lshl_add_u32 v4, v3, 1, v4
  s_lshl_b32 s67, s62, 2
  v_add_u32 v4, s67, v4
  v_bfe_u32 v5, v0, 3, 1
  v_lshlrev_b32 v5, 2, v5
  v_xor_b32 v4, v4, v5
  v_lshlrev_b32 v4, 4, v4
  v_lshl_add_u32 v4, v2, 7, v4
  v_and_b32 v5, 1, v0
  v_lshl_add_u32 v22, v5, 3, v4
  s_lshr_b32 s67, s61, 1
  s_xor_b32 s67, s67, s62
  s_lshl_b32 s68, s67, 6
  v_xor_b32 v28, s68, v22
  s_lshl_b32 s69, s67, 5
  s_add_u32 s66, s61, 0
  s_and_b32 s66, s66, 3
  s_mul_i32 s66, s66, 2048
  v_add_u32 v18, s66, v22
  s_add_u32 s66, s61, 1
  s_and_b32 s66, s66, 3
  s_mul_i32 s66, s66, 2048
  v_add_u32 v19, s66, v22
  s_add_u32 s66, s61, 2
  s_and_b32 s66, s66, 3
  s_mul_i32 s66, s66, 2048
  v_add_u32 v20, s66, v22
  s_add_u32 s66, s61, 3
  s_and_b32 s66, s66, 3
  s_mul_i32 s66, s66, 2048
  v_add_u32 v21, s66, v22
  v_lshlrev_b32 v2, 6, v2
  v_lshl_add_u32 v2, v3, 12, v2
  v_bfe_u32 v4, v0, 1, 1
  s_lshl_b32 s67, s62, 1
  v_add_u32 v4, s67, v4
  v_lshlrev_b32 v3, 1, v3
  v_xor_b32 v4, v4, v3
  v_lshl_add_u32 v2, v4, 4, v2
  v_lshl_add_u32 v5, v5, 3, v2
  v_xor_b32 v29, s69, v5
  s_add_u32 s66, s61, 0
  s_and_b32 s66, s66, 3
  s_mul_i32 s66, s66, 1024
  v_add_u32 v22, s66, v5
  s_add_u32 s66, s61, 1
  s_and_b32 s66, s66, 3
  s_mul_i32 s66, s66, 1024
  v_add_u32 v23, s66, v5
  s_add_u32 s66, s61, 2
  s_and_b32 s66, s66, 3
  s_mul_i32 s66, s66, 1024
  v_add_u32 v24, s66, v5
  s_add_u32 s66, s61, 3
  s_and_b32 s66, s66, 3
  s_mul_i32 s66, s66, 1024
  v_add_u32 v25, s66, v5
  v_mov_b32 v30, 0
  v_mov_b32 v31, 0
  v_mov_b32 v32, 0
  v_mov_b32 v33, 0
  s_lshl_b32 s66, s64, 1
  s_add_u32 s66, s66, s62
  s_lshl_b32 s66, s66, 10
  s_add_u32 m0, s77, 147456
  s_nop 0
  buffer_load_dwordx4 v1, s[52:55], s66 offen lds
  s_lshl_b32 s94, s61, 11
  s_add_u32 s94, s94, s93
  s_add_u32 s84, s88, 2048
  s_add_u32 s82, s94, 8192
  s_add_u32 s71, s65, 0
  s_and_b32 s71, s71, 7
  s_mul_i32 s73, s71, 196608
  s_add_u32 m0, s77, 131072
  s_nop 0
  buffer_load_dwordx4 v12, s[48:51], s73 offen lds
  s_add_u32 s71, s65, 0
  s_and_b32 s71, s71, 7
  s_mul_i32 s85, s71, 176128
  s_add_u32 m0, s77, 139264
  s_nop 0
  buffer_load_dwordx4 v13, s[44:47], s85 offen lds
  s_waitcnt vmcnt(7)
  s_barrier
  v_mov_b32 v2, 0
  buffer_load_dwordx2 v[220:221], v2, s[56:59], 0 offen offset:128 sc1
  ds_read_b128 v[36:39], v14 offset:0
  ds_read_b64_tr_b16 v[228:229], v18 offset:16384
  ds_read_b64_tr_b16 v[230:231], v18 offset:16896
  ds_read_b64_tr_b16 v[232:233], v18 offset:24576
  ds_read_b64_tr_b16 v[234:235], v18 offset:25088
  ds_read_b128 v[40:43], v15 offset:0
  ds_read_b64_tr_b16 v[212:213], v19 offset:16384
  ds_read_b64_tr_b16 v[214:215], v19 offset:16896
  ds_read_b64_tr_b16 v[216:217], v19 offset:24576
  ds_read_b64_tr_b16 v[218:219], v19 offset:25088
  s_add_u32 s71, s65, 2
  s_and_b32 s71, s71, 7
  s_lshl_b32 s72, s71, 7
  s_add_u32 m0, s76, 65536
  s_mul_i32 s73, s71, 196608
  buffer_load_dwordx4 v10, s[32:35], s72 offen lds
  buffer_load_dwordx4 v11, s[32:35], s72 offen offset:1024 lds
  s_cmp_lg_u32 s62, 0
  s_cbranch_scc1 ALelse_56
  s_and_b32 s66, s61, 1
  s_lshl_b32 s66, s66, 13
  v_add_u32 v2, s66, v28
  ds_read_b64_tr_b16 v[196:197], v2 offset:16384
  ds_read_b64_tr_b16 v[198:199], v2 offset:16896
  ds_read_b64_tr_b16 v[200:201], v2 offset:18432
  ds_read_b64_tr_b16 v[202:203], v2 offset:18944
  ds_read_b64_tr_b16 v[204:205], v2 offset:20480
  ds_read_b64_tr_b16 v[206:207], v2 offset:20992
  ds_read_b64_tr_b16 v[208:209], v2 offset:22528
  ds_read_b64_tr_b16 v[210:211], v2 offset:23040
  s_waitcnt lgkmcnt(7)
  v_lshlrev_b32 v2, 16, v196
  v_and_b32 v3, 0xffff0000, v196
  v_lshlrev_b32 v4, 16, v197
  v_and_b32 v5, 0xffff0000, v197
  v_pk_add_f32 v[6:7], v[2:3], v[4:5]
  s_waitcnt lgkmcnt(6)
  v_lshlrev_b32 v2, 16, v198
  v_and_b32 v3, 0xffff0000, v198
  v_lshlrev_b32 v4, 16, v199
  v_and_b32 v5, 0xffff0000, v199
  v_pk_add_f32 v[6:7], v[6:7], v[2:3]
  v_pk_add_f32 v[6:7], v[6:7], v[4:5]
  s_waitcnt lgkmcnt(5)
  v_lshlrev_b32 v2, 16, v200
  v_and_b32 v3, 0xffff0000, v200
  v_lshlrev_b32 v4, 16, v201
  v_and_b32 v5, 0xffff0000, v201
  v_pk_add_f32 v[6:7], v[6:7], v[2:3]
  v_pk_add_f32 v[6:7], v[6:7], v[4:5]
  s_waitcnt lgkmcnt(4)
  v_lshlrev_b32 v2, 16, v202
  v_and_b32 v3, 0xffff0000, v202
  v_lshlrev_b32 v4, 16, v203
  v_and_b32 v5, 0xffff0000, v203
  v_pk_add_f32 v[6:7], v[6:7], v[2:3]
  v_pk_add_f32 v[6:7], v[6:7], v[4:5]
  s_waitcnt lgkmcnt(3)
  v_lshlrev_b32 v2, 16, v204
  v_and_b32 v3, 0xffff0000, v204
  v_lshlrev_b32 v4, 16, v205
  v_and_b32 v5, 0xffff0000, v205
  v_pk_add_f32 v[6:7], v[6:7], v[2:3]
  v_pk_add_f32 v[6:7], v[6:7], v[4:5]
  s_waitcnt lgkmcnt(2)
  v_lshlrev_b32 v2, 16, v206
  v_and_b32 v3, 0xffff0000, v206
  v_lshlrev_b32 v4, 16, v207
  v_and_b32 v5, 0xffff0000, v207
  v_pk_add_f32 v[6:7], v[6:7], v[2:3]
  v_pk_add_f32 v[6:7], v[6:7], v[4:5]
  s_waitcnt lgkmcnt(1)
  v_lshlrev_b32 v2, 16, v208
  v_and_b32 v3, 0xffff0000, v208
  v_lshlrev_b32 v4, 16, v209
  v_and_b32 v5, 0xffff0000, v209
  v_pk_add_f32 v[6:7], v[6:7], v[2:3]
  v_pk_add_f32 v[6:7], v[6:7], v[4:5]
  s_waitcnt lgkmcnt(0)
  v_lshlrev_b32 v2, 16, v210
  v_and_b32 v3, 0xffff0000, v210
  v_lshlrev_b32 v4, 16, v211
  v_and_b32 v5, 0xffff0000, v211
  v_pk_add_f32 v[6:7], v[6:7], v[2:3]
  v_pk_add_f32 v[6:7], v[6:7], v[4:5]
  v_add_f32 v6, v6, v7
  v_mov_b32 v7, v6
  s_nop 1
  v_permlane32_swap_b32 v6, v7
  v_add_f32 v26, v6, v7
  s_branch ALend_57
ALelse_56:
  ds_read_b128 v[44:47], v16
  ds_read_b128 v[48:51], v17
  s_waitcnt lgkmcnt(11)
  v_lshlrev_b32 v2, 16, v36
  v_and_b32 v3, 0xffff0000, v36
  v_lshlrev_b32 v4, 16, v37
  v_and_b32 v5, 0xffff0000, v37
  v_add_f32 v30, v30, v2
  v_add_f32 v31, v31, v3
  v_fmac_f32 v32, v2, v2
  v_fmac_f32 v33, v3, v3
  v_add_f32 v30, v30, v4
  v_add_f32 v31, v31, v5
  v_fmac_f32 v32, v4, v4
  v_fmac_f32 v33, v5, v5
  v_lshlrev_b32 v2, 16, v38
  v_and_b32 v3, 0xffff0000, v38
  v_lshlrev_b32 v4, 16, v39
  v_and_b32 v5, 0xffff0000, v39
  v_add_f32 v30, v30, v2
  v_add_f32 v31, v31, v3
  v_fmac_f32 v32, v2, v2
  v_fmac_f32 v33, v3, v3
  v_add_f32 v30, v30, v4
  v_add_f32 v31, v31, v5
  v_fmac_f32 v32, v4, v4
  v_fmac_f32 v33, v5, v5
  s_waitcnt lgkmcnt(6)
  v_lshlrev_b32 v2, 16, v40
  v_and_b32 v3, 0xffff0000, v40
  v_lshlrev_b32 v4, 16, v41
  v_and_b32 v5, 0xffff0000, v41
  v_add_f32 v30, v30, v2
  v_add_f32 v31, v31, v3
  v_fmac_f32 v32, v2, v2
  v_fmac_f32 v33, v3, v3
  v_add_f32 v30, v30, v4
  v_add_f32 v31, v31, v5
  v_fmac_f32 v32, v4, v4
  v_fmac_f32 v33, v5, v5
  v_lshlrev_b32 v2, 16, v42
  v_and_b32 v3, 0xffff0000, v42
  v_lshlrev_b32 v4, 16, v43
  v_and_b32 v5, 0xffff0000, v43
  v_add_f32 v30, v30, v2
  v_add_f32 v31, v31, v3
  v_fmac_f32 v32, v2, v2
  v_fmac_f32 v33, v3, v3
  v_add_f32 v30, v30, v4
  v_add_f32 v31, v31, v5
  v_fmac_f32 v32, v4, v4
  v_fmac_f32 v33, v5, v5
  s_waitcnt lgkmcnt(1)
  v_lshlrev_b32 v2, 16, v44
  v_and_b32 v3, 0xffff0000, v44
  v_lshlrev_b32 v4, 16, v45
  v_and_b32 v5, 0xffff0000, v45
  v_add_f32 v30, v30, v2
  v_add_f32 v31, v31, v3
  v_fmac_f32 v32, v2, v2
  v_fmac_f32 v33, v3, v3
  v_add_f32 v30, v30, v4
  v_add_f32 v31, v31, v5
  v_fmac_f32 v32, v4, v4
  v_fmac_f32 v33, v5, v5
  v_lshlrev_b32 v2, 16, v46
  v_and_b32 v3, 0xffff0000, v46
  v_lshlrev_b32 v4, 16, v47
  v_and_b32 v5, 0xffff0000, v47
  v_add_f32 v30, v30, v2
  v_add_f32 v31, v31, v3
  v_fmac_f32 v32, v2, v2
  v_fmac_f32 v33, v3, v3
  v_add_f32 v30, v30, v4
  v_add_f32 v31, v31, v5
  v_fmac_f32 v32, v4, v4
  v_fmac_f32 v33, v5, v5
  s_waitcnt lgkmcnt(0)
  v_lshlrev_b32 v2, 16, v48
  v_and_b32 v3, 0xffff0000, v48
  v_lshlrev_b32 v4, 16, v49
  v_and_b32 v5, 0xffff0000, v49
  v_add_f32 v30, v30, v2
  v_add_f32 v31, v31, v3
  v_fmac_f32 v32, v2, v2
  v_fmac_f32 v33, v3, v3
  v_add_f32 v30, v30, v4
  v_add_f32 v31, v31, v5
  v_fmac_f32 v32, v4, v4
  v_fmac_f32 v33, v5, v5
  v_lshlrev_b32 v2, 16, v50
  v_and_b32 v3, 0xffff0000, v50
  v_lshlrev_b32 v4, 16, v51
  v_and_b32 v5, 0xffff0000, v51
  v_add_f32 v30, v30, v2
  v_add_f32 v31, v31, v3
  v_fmac_f32 v32, v2, v2
  v_fmac_f32 v33, v3, v3
  v_add_f32 v30, v30, v4
  v_add_f32 v31, v31, v5
  v_fmac_f32 v32, v4, v4
  v_fmac_f32 v33, v5, v5
  v_add_f32 v30, v30, v31
  v_add_f32 v31, v32, v33
  s_nop 1
  v_permlane32_swap_b32 v30, v31
  v_add_f32 v30, v30, v31
  v_mov_b32 v31, v30
  s_nop 1
  v_permlane32_swap_b32 v30, v31
  v_mov_b32 v248, v30
  v_mov_b32 v250, v31
ALend_57:
  v_mfma_f32_32x32x16_bf16 v[164:179], v[228:231], v[36:39], 0
  ds_read_b128 v[44:47], v16 offset:0
  ds_read_b64_tr_b16 v[236:237], v20 offset:16384
  ds_read_b64_tr_b16 v[238:239], v20 offset:16896
  v_mfma_f32_32x32x16_bf16 v[180:195], v[232:235], v[36:39], 0
  s_add_u32 m0, s77, 80896
  s_add_u32 s85, s73, 2048
  buffer_load_dwordx4 v12, s[48:51], s73 offen offset:1024 lds
  ds_read_b64_tr_b16 v[240:241], v20 offset:24576
  ds_read_b64_tr_b16 v[242:243], v20 offset:25088
  v_mfma_f32_32x32x16_bf16 v[164:179], v[212:215], v[40:43], v[164:179]
  ds_read_b128 v[48:51], v17 offset:0
  ds_read_b64_tr_b16 v[228:229], v21 offset:16384
  ds_read_b64_tr_b16 v[230:231], v21 offset:16896
  v_mfma_f32_32x32x16_bf16 v[180:195], v[216:219], v[40:43], v[180:195]
  s_add_u32 m0, s77, 90112
  s_nop 0
  buffer_load_dwordx4 v12, s[48:51], s85 offen lds
  ds_read_b64_tr_b16 v[232:233], v21 offset:24576
  ds_read_b64_tr_b16 v[234:235], v21 offset:25088
  s_waitcnt vmcnt(8)
  s_barrier
  s_waitcnt lgkmcnt(7)
  v_mfma_f32_32x32x16_bf16 v[164:179], v[236:239], v[44:47], v[164:179]
  ds_read_b128 v[52:55], v14 offset:32768
  ds_read_b64_tr_b16 v[212:213], v18 offset:49152
  ds_read_b64_tr_b16 v[214:215], v18 offset:49664
  s_waitcnt lgkmcnt(8)
  v_mfma_f32_32x32x16_bf16 v[180:195], v[240:243], v[44:47], v[180:195]
  s_add_u32 s71, s65, 3
  s_and_b32 s71, s71, 7
  s_lshl_b32 s72, s71, 7
  s_add_u32 m0, s76, 98304
  s_mul_i32 s73, s71, 196608
  buffer_load_dwordx4 v10, s[32:35], s72 offen lds
  ds_read_b64_tr_b16 v[216:217], v18 offset:57344
  ds_read_b64_tr_b16 v[218:219], v18 offset:57856
  s_waitcnt lgkmcnt(7)
  v_mfma_f32_32x32x16_bf16 v[164:179], v[228:231], v[48:51], v[164:179]
  ds_read_b128 v[56:59], v15 offset:32768
  v_mov_b32 v2, 128
  ds_read_b64_tr_b16 v[236:237], v19 offset:49152
  s_waitcnt vmcnt(5)
  v_readfirstlane_b32 s90, v220
  ds_read_b64_tr_b16 v[238:239], v19 offset:49664
  s_waitcnt lgkmcnt(8)
  v_mfma_f32_32x32x16_bf16 v[180:195], v[232:235], v[48:51], v[180:195]
  buffer_load_dwordx4 v11, s[32:35], s72 offen offset:1024 lds
  v_readfirstlane_b32 s91, v221
  ds_read_b64_tr_b16 v[240:241], v19 offset:57344
  s_cmp_lg_u64 s[90:91], 0
  s_cbranch_scc0 ALrare_58
ALback_59:
  ds_read_b64_tr_b16 v[242:243], v19 offset:57856
  s_waitcnt lgkmcnt(7)
  v_mfma_f32_32x32x16_bf16 v[164:179], v[212:215], v[52:55], v[164:179]
  ds_read_b128 v[60:63], v16 offset:32768
  ds_read_b64_tr_b16 v[228:229], v20 offset:49152
  ds_read_b64_tr_b16 v[230:231], v20 offset:49664
  s_add_u32 m0, s77, 113664
  s_add_u32 s85, s73, 2048
  buffer_load_dwordx4 v12, s[48:51], s73 offen offset:1024 lds
  s_waitcnt lgkmcnt(8)
  v_mfma_f32_32x32x16_bf16 v[180:195], v[216:219], v[52:55], v[180:195]
  s_cmp_lg_u32 s62, 0
  s_cbranch_scc1 ALskip_62
  v_mov_b32 v27, s90
  s_lshl_b32 s66, s61, 11
  s_add_u32 s66, s66, s93
  s_and_b32 s67, s63, 6
  s_lshl_b32 s67, s67, 8
  s_add_u32 s66, s66, s67
  s_and_b32 s67, s63, 1
  s_lshl_b32 s67, s67, 3
  s_add_u32 s66, s66, s67
  s_mov_b64 exec, 0xffffffff
  buffer_store_dwordx2 v[26:27], v1, s[28:31], s66 offen sc1
  s_mov_b64 exec, -1
ALskip_62:
  ds_read_b64_tr_b16 v[232:233], v20 offset:57344
  ds_read_b64_tr_b16 v[234:235], v20 offset:57856
  s_waitcnt lgkmcnt(7)
  v_mfma_f32_32x32x16_bf16 v[164:179], v[236:239], v[56:59], v[164:179]
  ds_read_b128 v[64:67], v17 offset:32768
  ds_read_b64_tr_b16 v[212:213], v21 offset:49152
  ds_read_b64_tr_b16 v[214:215], v21 offset:49664
  s_add_u32 m0, s77, 122880
  s_nop 0
  buffer_load_dwordx4 v12, s[48:51], s85 offen lds
  s_waitcnt lgkmcnt(8)
  v_mfma_f32_32x32x16_bf16 v[180:195], v[240:243], v[56:59], v[180:195]
  s_cmp_lg_u32 s62, 1
  s_cbranch_scc1 ALskip_63
  v_mov_b32 v249, s90
  v_mov_b32 v251, s90
  s_lshl_b32 s66, s64, 9
  s_add_u32 s66, s66, s88
  s_mov_b64 exec, 0xffffffff
  buffer_store_dwordx4 v[248:251], v1, s[28:31], s66 offen sc1
  s_mov_b64 exec, -1
ALskip_63:
  ds_read_b64_tr_b16 v[216:217], v21 offset:57344
  ds_read_b64_tr_b16 v[218:219], v21 offset:57856
  s_waitcnt vmcnt(5)
  s_barrier
  s_waitcnt lgkmcnt(7)
  v_mfma_f32_32x32x16_bf16 v[164:179], v[228:231], v[60:63], v[164:179]
  v_bfe_u32 v2, v0, 4, 1
  v_add_u32 v14, 65536, v14
  v_add_u32 v15, 65536, v15
  v_add_u32 v16, 65536, v16
  v_add_u32 v17, 65536, v17
  ds_read_b128 v[68:71], v14 offset:0
  v_lshlrev_b32 v2, 9, v2
  v_add_u32 v18, 65536, v18
  v_add_u32 v19, 65536, v19
  v_add_u32 v20, 65536, v20
  v_add_u32 v21, 65536, v21
  ds_read_b64_tr_b16 v[236:237], v18 offset:16384
  v_lshrrev_b32 v3, 5, v0
  v_lshl_add_u32 v2, v3, 7, v2
  ds_read_b64_tr_b16 v[238:239], v18 offset:16896
  s_waitcnt lgkmcnt(8)
  v_mfma_f32_32x32x16_bf16 v[180:195], v[232:235], v[60:63], v[180:195]
  s_add_u32 s71, s65, 4
  s_and_b32 s71, s71, 7
  s_lshl_b32 s72, s71, 7
  s_add_u32 m0, s76, 0
  s_mul_i32 s73, s71, 196608
  buffer_load_dwordx4 v10, s[32:35], s72 offen lds
  v_and_b32 v3, 15, v0
  v_lshl_add_u32 v2, v3, 3, v2
  ds_read_b64_tr_b16 v[240:241], v18 offset:24576
  s_lshl_b32 s66, s60, 10
  ds_read_b64_tr_b16 v[242:243], v18 offset:25088
  s_add_u32 s66, s66, 147456
  s_waitcnt lgkmcnt(7)
  v_mfma_f32_32x32x16_bf16 v[164:179], v[212:215], v[64:67], v[164:179]
  ds_read_b128 v[72:75], v15 offset:0
  v_add_u32 v2, s66, v2
  ds_read_b64_tr_b16 v[228:229], v19 offset:16384
  ds_read_b64_tr_b16 v[230:231], v19 offset:16896
  s_waitcnt lgkmcnt(8)
  v_mfma_f32_32x32x16_bf16 v[180:195], v[216:219], v[64:67], v[180:195]
  buffer_load_dwordx4 v11, s[32:35], s72 offen offset:1024 lds
  ds_read_b64_tr_b16 v[244:245], v2
  ds_read_b64_tr_b16 v[232:233], v19 offset:24576
  ds_read_b64_tr_b16 v[246:247], v2 offset:256
  ds_read_b64_tr_b16 v[234:235], v19 offset:25088
  s_waitcnt lgkmcnt(9)
  v_mfma_f32_32x32x16_bf16 v[164:179], v[236:239], v[68:71], v[164:179]
  ds_read_b128 v[76:79], v16 offset:0
  ds_read_b64_tr_b16 v[212:213], v20 offset:16384
  ds_read_b64_tr_b16 v[214:215], v20 offset:16896
  s_add_u32 m0, s77, 15360
  s_add_u32 s85, s73, 2048
  buffer_load_dwordx4 v12, s[48:51], s73 offen offset:1024 lds
  s_waitcnt lgkmcnt(10)
  v_mfma_f32_32x32x16_bf16 v[180:195], v[240:243], v[68:71], v[180:195]
  s_cmp_lg_u32 s62, 1
  s_cbranch_scc1 ALskip_64
  s_bitcmp1_b32 s61, 0
  s_cbranch_scc1 ALelse_65
  v_add_u32 v2, 131072, v28
  ds_read_b64_tr_b16 v[196:197], v2 offset:0
  ds_read_b64_tr_b16 v[198:199], v2 offset:512
  ds_read_b64_tr_b16 v[200:201], v2 offset:2048
  ds_read_b64_tr_b16 v[202:203], v2 offset:2560
  ds_read_b64_tr_b16 v[204:205], v2 offset:4096
  ds_read_b64_tr_b16 v[206:207], v2 offset:4608
  ds_read_b64_tr_b16 v[208:209], v2 offset:6144
  ds_read_b64_tr_b16 v[210:211], v2 offset:6656
  s_branch ALend_66
ALelse_65:
  v_add_u32 v2, 139264, v29
  ds_read_b64_tr_b16 v[196:197], v2 offset:0
  ds_read_b64_tr_b16 v[198:199], v2 offset:256
  ds_read_b64_tr_b16 v[200:201], v2 offset:1024
  ds_read_b64_tr_b16 v[202:203], v2 offset:1280
  ds_read_b64_tr_b16 v[204:205], v2 offset:2048
  ds_read_b64_tr_b16 v[206:207], v2 offset:2304
  ds_read_b64_tr_b16 v[208:209], v2 offset:3072
  ds_read_b64_tr_b16 v[210:211], v2 offset:3328
ALend_66:
  s_add_u32 s68, s61, 4
  s_waitcnt lgkmcnt(7)
  v_lshlrev_b32 v2, 16, v196
  v_and_b32 v3, 0xffff0000, v196
  v_lshlrev_b32 v4, 16, v197
  v_and_b32 v5, 0xffff0000, v197
  v_pk_add_f32 v[6:7], v[2:3], v[4:5]
  s_waitcnt lgkmcnt(6)
  v_lshlrev_b32 v2, 16, v198
  v_and_b32 v3, 0xffff0000, v198
  v_lshlrev_b32 v4, 16, v199
  v_and_b32 v5, 0xffff0000, v199
  v_pk_add_f32 v[6:7], v[6:7], v[2:3]
  v_pk_add_f32 v[6:7], v[6:7], v[4:5]
  s_waitcnt lgkmcnt(5)
  v_lshlrev_b32 v2, 16, v200
  v_and_b32 v3, 0xffff0000, v200
  v_lshlrev_b32 v4, 16, v201
  v_and_b32 v5, 0xffff0000, v201
  v_pk_add_f32 v[6:7], v[6:7], v[2:3]
  v_pk_add_f32 v[6:7], v[6:7], v[4:5]
  s_waitcnt lgkmcnt(4)
  v_lshlrev_b32 v2, 16, v202
  v_and_b32 v3, 0xffff0000, v202
  v_lshlrev_b32 v4, 16, v203
  v_and_b32 v5, 0xffff0000, v203
  v_pk_add_f32 v[6:7], v[6:7], v[2:3]
  v_pk_add_f32 v[6:7], v[6:7], v[4:5]
  s_waitcnt lgkmcnt(3)
  v_lshlrev_b32 v2, 16, v204
  v_and_b32 v3, 0xffff0000, v204
  v_lshlrev_b32 v4, 16, v205
  v_and_b32 v5, 0xffff0000, v205
  v_pk_add_f32 v[6:7], v[6:7], v[2:3]
  v_pk_add_f32 v[6:7], v[6:7], v[4:5]
  s_waitcnt lgkmcnt(2)
  v_lshlrev_b32 v2, 16, v206
  v_and_b32 v3, 0xffff0000, v206
  v_lshlrev_b32 v4, 16, v207
  v_and_b32 v5, 0xffff0000, v207
  v_pk_add_f32 v[6:7], v[6:7], v[2:3]
  v_pk_add_f32 v[6:7], v[6:7], v[4:5]
  s_waitcnt lgkmcnt(1)
  v_lshlrev_b32 v2, 16, v208
  v_and_b32 v3, 0xffff0000, v208
  v_lshlrev_b32 v4, 16, v209
  v_and_b32 v5, 0xffff0000, v209
  v_pk_add_f32 v[6:7], v[6:7], v[2:3]
  v_pk_add_f32 v[6:7], v[6:7], v[4:5]
  s_waitcnt lgkmcnt(0)
  v_lshlrev_b32 v2, 16, v210
  v_and_b32 v3, 0xffff0000, v210
  v_lshlrev_b32 v4, 16, v211
  v_and_b32 v5, 0xffff0000, v211
  v_pk_add_f32 v[6:7], v[6:7], v[2:3]
  v_pk_add_f32 v[6:7], v[6:7], v[4:5]
  v_add_f32 v6, v6, v7
  v_mov_b32 v7, v6
  s_nop 1
  v_permlane32_swap_b32 v6, v7
  v_add_f32 v26, v6, v7
  v_mov_b32 v27, s90
  s_lshl_b32 s66, s68, 11
  s_add_u32 s66, s66, s93
  s_and_b32 s67, s63, 6
  s_lshl_b32 s67, s67, 8
  s_add_u32 s66, s66, s67
  s_and_b32 s67, s63, 1
  s_lshl_b32 s67, s67, 3
  s_add_u32 s66, s66, s67
  s_mov_b64 exec, 0xffffffff
  buffer_store_dwordx2 v[26:27], v1, s[28:31], s66 offen sc1
  s_mov_b64 exec, -1
ALskip_64:
  ds_read_b64_tr_b16 v[216:217], v20 offset:24576
  ds_read_b64_tr_b16 v[218:219], v20 offset:25088
  s_waitcnt lgkmcnt(9)
  v_mfma_f32_32x32x16_bf16 v[164:179], v[228:231], v[72:75], v[164:179]
  ds_read_b128 v[80:83], v17 offset:0
  ds_read_b64_tr_b16 v[236:237], v21 offset:16384
  ds_read_b64_tr_b16 v[238:239], v21 offset:16896
  s_waitcnt lgkmcnt(8)
  v_mfma_f32_32x32x16_bf16 v[180:195], v[232:235], v[72:75], v[180:195]
  s_add_u32 m0, s77, 24576
  s_nop 0
  buffer_load_dwordx4 v12, s[48:51], s85 offen lds
  ds_read_b64_tr_b16 v[240:241], v21 offset:24576
  ds_read_b64_tr_b16 v[242:243], v21 offset:25088
  s_waitcnt vmcnt(4)
  s_barrier
  s_waitcnt lgkmcnt(7)
  v_mfma_f32_32x32x16_bf16 v[164:179], v[212:215], v[76:79], v[164:179]
  ds_read_b128 v[84:87], v14 offset:32768
  ds_read_b64_tr_b16 v[228:229], v18 offset:49152
  ds_read_b64_tr_b16 v[230:231], v18 offset:49664
  s_waitcnt lgkmcnt(8)
  v_mfma_f32_32x32x16_bf16 v[180:195], v[216:219], v[76:79], v[180:195]
  s_add_u32 s71, s65, 5
  s_and_b32 s71, s71, 7
  s_lshl_b32 s72, s71, 7
  s_add_u32 m0, s76, 32768
  s_mul_i32 s73, s71, 196608
  buffer_load_dwordx4 v10, s[32:35], s72 offen lds
  ds_read_b64_tr_b16 v[232:233], v18 offset:57344
  ds_read_b64_tr_b16 v[234:235], v18 offset:57856
  s_waitcnt lgkmcnt(7)
  v_mfma_f32_32x32x16_bf16 v[164:179], v[236:239], v[80:83], v[164:179]
  ds_read_b128 v[88:91], v15 offset:32768
  ds_read_b64_tr_b16 v[212:213], v19 offset:49152
  ds_read_b64_tr_b16 v[214:215], v19 offset:49664
  s_waitcnt lgkmcnt(8)
  v_mfma_f32_32x32x16_bf16 v[180:195], v[240:243], v[80:83], v[180:195]
  buffer_load_dwordx4 v11, s[32:35], s72 offen offset:1024 lds
  ds_read_b64_tr_b16 v[216:217], v19 offset:57344
  ds_read_b64_tr_b16 v[218:219], v19 offset:57856
  s_waitcnt lgkmcnt(7)
  v_mfma_f32_32x32x16_bf16 v[164:179], v[228:231], v[84:87], v[164:179]
  ds_read_b128 v[92:95], v16 offset:32768
  ds_read_b64_tr_b16 v[236:237], v20 offset:49152
  ds_read_b64_tr_b16 v[238:239], v20 offset:49664
  s_waitcnt lgkmcnt(8)
  v_mfma_f32_32x32x16_bf16 v[180:195], v[232:235], v[84:87], v[180:195]
  s_add_u32 m0, s77, 48128
  s_add_u32 s85, s73, 2048
  buffer_load_dwordx4 v12, s[48:51], s73 offen offset:1024 lds
  ds_read_b64_tr_b16 v[240:241], v20 offset:57344
  ds_read_b64_tr_b16 v[242:243], v20 offset:57856
  s_waitcnt lgkmcnt(7)
  v_mfma_f32_32x32x16_bf16 v[164:179], v[212:215], v[88:91], v[164:179]
  ds_read_b128 v[96:99], v17 offset:32768
  ds_read_b64_tr_b16 v[228:229], v21 offset:49152
  ds_read_b64_tr_b16 v[230:231], v21 offset:49664
  s_waitcnt lgkmcnt(8)
  v_mfma_f32_32x32x16_bf16 v[180:195], v[216:219], v[88:91], v[180:195]
  s_add_u32 m0, s77, 57344
  s_nop 0
  buffer_load_dwordx4 v12, s[48:51], s85 offen lds
  ds_read_b64_tr_b16 v[232:233], v21 offset:57344
  ds_read_b64_tr_b16 v[234:235], v21 offset:57856
  s_waitcnt vmcnt(4)
  s_barrier
  s_waitcnt lgkmcnt(7)
  v_mfma_f32_32x32x16_bf16 v[164:179], v[236:239], v[92:95], v[164:179]
  v_add_u32 v14, 4294901760, v14
  v_add_u32 v15, 4294901760, v15
  v_add_u32 v16, 4294901760, v16
  v_add_u32 v17, 4294901760, v17
  ds_read_b128 v[100:103], v14 offset:0
  v_add_u32 v18, 4294901760, v18
  v_add_u32 v19, 4294901760, v19
  v_add_u32 v20, 4294901760, v20
  v_add_u32 v21, 4294901760, v21
  ds_read_b64_tr_b16 v[212:213], v18 offset:16384
  ds_read_b64_tr_b16 v[214:215], v18 offset:16896
  s_waitcnt lgkmcnt(8)
  v_mfma_f32_32x32x16_bf16 v[180:195], v[240:243], v[92:95], v[180:195]
  s_add_u32 s71, s65, 6
  s_and_b32 s71, s71, 7
  s_lshl_b32 s72, s71, 7
  s_add_u32 m0, s76, 65536
  s_mul_i32 s73, s71, 196608
  buffer_load_dwordx4 v10, s[32:35], s72 offen lds
  ds_read_b64_tr_b16 v[216:217], v18 offset:24576
  ds_read_b64_tr_b16 v[218:219], v18 offset:25088
  s_waitcnt lgkmcnt(7)
  v_mfma_f32_32x32x16_bf16 v[164:179], v[228:231], v[96:99], v[164:179]
  ds_read_b128 v[104:107], v15 offset:0
  ds_read_b64_tr_b16 v[236:237], v19 offset:16384
  ds_read_b64_tr_b16 v[238:239], v19 offset:16896
  s_waitcnt lgkmcnt(8)
  v_mfma_f32_32x32x16_bf16 v[180:195], v[232:235], v[96:99], v[180:195]
  buffer_load_dwordx4 v11, s[32:35], s72 offen offset:1024 lds
  ds_read_b64_tr_b16 v[240:241], v19 offset:24576
  ds_read_b64_tr_b16 v[242:243], v19 offset:25088
  s_waitcnt lgkmcnt(7)
  v_mfma_f32_32x32x16_bf16 v[164:179], v[212:215], v[100:103], v[164:179]
  ds_read_b128 v[108:111], v16 offset:0
  ds_read_b64_tr_b16 v[228:229], v20 offset:16384
  ds_read_b64_tr_b16 v[230:231], v20 offset:16896
  s_waitcnt lgkmcnt(8)
  v_mfma_f32_32x32x16_bf16 v[180:195], v[216:219], v[100:103], v[180:195]
  s_add_u32 m0, s77, 80896
  s_add_u32 s85, s73, 2048
  buffer_load_dwordx4 v12, s[48:51], s73 offen offset:1024 lds
  ds_read_b64_tr_b16 v[232:233], v20 offset:24576
  ds_read_b64_tr_b16 v[234:235], v20 offset:25088
  s_waitcnt lgkmcnt(7)
  v_mfma_f32_32x32x16_bf16 v[164:179], v[236:239], v[104:107], v[164:179]
  ds_read_b128 v[112:115], v17 offset:0
  ds_read_b64_tr_b16 v[212:213], v21 offset:16384
  ds_read_b64_tr_b16 v[214:215], v21 offset:16896
  s_waitcnt lgkmcnt(8)
  v_mfma_f32_32x32x16_bf16 v[180:195], v[240:243], v[104:107], v[180:195]
  s_add_u32 m0, s77, 90112
  s_nop 0
  buffer_load_dwordx4 v12, s[48:51], s85 offen lds
  ds_read_b64_tr_b16 v[216:217], v21 offset:24576
  ds_read_b64_tr_b16 v[218:219], v21 offset:25088
  s_waitcnt vmcnt(4)
  s_barrier
  s_waitcnt lgkmcnt(7)
  v_mfma_f32_32x32x16_bf16 v[164:179], v[228:231], v[108:111], v[164:179]
  s_cmp_eq_u32 s62, 0
  s_cselect_b32 s81, s94, s88
  s_cselect_b32 s79, s82, s84
  ds_read_b128 v[116:119], v14 offset:32768
  s_add_u32 s66, s81, 0
  ds_read_b64_tr_b16 v[236:237], v18 offset:49152
  buffer_load_dwordx4 v[196:199], v1, s[28:31], s66 offen offset:0 sc1
  ds_read_b64_tr_b16 v[238:239], v18 offset:49664
  s_add_u32 s71, s65, 7
  s_and_b32 s71, s71, 7
  s_lshl_b32 s72, s71, 7
  s_add_u32 m0, s76, 98304
  s_mul_i32 s73, s71, 196608
  buffer_load_dwordx4 v10, s[32:35], s72 offen lds
  s_waitcnt lgkmcnt(8)
  v_mfma_f32_32x32x16_bf16 v[180:195], v[232:235], v[108:111], v[180:195]
  buffer_load_dwordx4 v[200:203], v1, s[28:31], s66 offen offset:1024 sc1
  s_add_u32 s66, s79, 0
  ds_read_b64_tr_b16 v[240:241], v18 offset:57344
  buffer_load_dwordx4 v[204:207], v1, s[28:31], s66 offen offset:0 sc1
  ds_read_b64_tr_b16 v[242:243], v18 offset:57856
  buffer_load_dwordx4 v[208:211], v1, s[28:31], s66 offen offset:1024 sc1
  s_waitcnt lgkmcnt(7)
  v_mfma_f32_32x32x16_bf16 v[164:179], v[212:215], v[112:115], v[164:179]
  ds_read_b128 v[120:123], v15 offset:32768
  ds_read_b64_tr_b16 v[228:229], v19 offset:49152
  ds_read_b64_tr_b16 v[230:231], v19 offset:49664
  s_waitcnt lgkmcnt(8)
  v_mfma_f32_32x32x16_bf16 v[180:195], v[216:219], v[112:115], v[180:195]
  buffer_load_dwordx4 v11, s[32:35], s72 offen offset:1024 lds
  ds_read_b64_tr_b16 v[232:233], v19 offset:57344
  ds_read_b64_tr_b16 v[234:235], v19 offset:57856
  s_waitcnt lgkmcnt(7)
  v_mfma_f32_32x32x16_bf16 v[164:179], v[236:239], v[116:119], v[164:179]
  v_and_b32 v2, 31, v0
  ds_read_b128 v[124:127], v16 offset:32768
  s_lshl_b32 s66, s61, 5
  ds_read_b64_tr_b16 v[212:213], v20 offset:49152
  v_add_u32 v2, s66, v2
  v_lshrrev_b32 v3, 5, v0
  ds_read_b64_tr_b16 v[214:215], v20 offset:49664
  s_waitcnt lgkmcnt(8)
  v_mfma_f32_32x32x16_bf16 v[180:195], v[240:243], v[116:119], v[180:195]
  s_add_u32 m0, s77, 113664
  s_add_u32 s85, s73, 2048
  buffer_load_dwordx4 v12, s[48:51], s73 offen offset:1024 lds
  v_mul_u32_u24 v4, 40, v2
  v_lshl_add_u32 v4, v3, 3, v4
  ds_read_b64_tr_b16 v[216:217], v20 offset:57344
  s_mul_i32 s66, s62, 10240
  ds_read_b64_tr_b16 v[218:219], v20 offset:57856
  s_add_u32 s66, s66, 73728
  s_waitcnt lgkmcnt(7)
  v_mfma_f32_32x32x16_bf16 v[164:179], v[228:231], v[120:123], v[164:179]
  v_add_u32 v30, s66, v4
  ds_read_b128 v[128:131], v17 offset:32768
  v_bfe_u32 v4, v0, 1, 3
  ds_read_b64_tr_b16 v[236:237], v21 offset:49152
  v_xor_b32 v4, v4, v3
  v_lshlrev_b32 v4, 3, v4
  ds_read_b64_tr_b16 v[238:239], v21 offset:49664
  s_waitcnt lgkmcnt(8)
  v_mfma_f32_32x32x16_bf16 v[180:195], v[232:235], v[120:123], v[180:195]
  s_add_u32 m0, s77, 122880
  s_nop 0
  buffer_load_dwordx4 v12, s[48:51], s85 offen lds
  v_lshl_add_u32 v4, v2, 6, v4
  s_lshl_b32 s66, s62, 14
  ds_read_b64_tr_b16 v[240:241], v21 offset:57344
  s_add_u32 s66, s66, 40960
  ds_read_b64_tr_b16 v[242:243], v21 offset:57856
  v_add_u32 v31, s66, v4
  s_waitcnt vmcnt(8)
  s_barrier
  s_waitcnt lgkmcnt(7)
  v_mfma_f32_32x32x16_bf16 v[164:179], v[212:215], v[124:127], v[164:179]
  v_add_u32 v14, 65536, v14
  v_add_u32 v15, 65536, v15
  v_add_u32 v16, 65536, v16
  v_add_u32 v17, 65536, v17
  ds_read_b128 v[132:135], v14 offset:0
  v_add_u32 v18, 65536, v18
  v_add_u32 v19, 65536, v19
  v_add_u32 v20, 65536, v20
  v_add_u32 v21, 65536, v21
  ds_read_b64_tr_b16 v[228:229], v18 offset:16384
  ds_read_b64_tr_b16 v[230:231], v18 offset:16896
  s_add_u32 s71, s65, 1
  s_and_b32 s71, s71, 7
  s_mul_i32 s73, s71, 196608
  s_add_u32 m0, s77, 147456
  s_nop 0
  buffer_load_dwordx4 v12, s[48:51], s73 offen lds
  s_waitcnt lgkmcnt(8)
  v_mfma_f32_32x32x16_bf16 v[180:195], v[216:219], v[124:127], v[180:195]
  v_xor_b32 v33, 16, v31
  ds_read_b64_tr_b16 v[232:233], v18 offset:24576
  ds_read_b64_tr_b16 v[234:235], v18 offset:25088
  s_waitcnt lgkmcnt(7)
  v_mfma_f32_32x32x16_bf16 v[164:179], v[236:239], v[128:131], v[164:179]
  ds_read_b128 v[136:139], v15 offset:0
  ds_read_b64_tr_b16 v[212:213], v19 offset:16384
  ds_read_b64_tr_b16 v[214:215], v19 offset:16896
  s_waitcnt lgkmcnt(8)
  v_mfma_f32_32x32x16_bf16 v[180:195], v[240:243], v[128:131], v[180:195]
  s_add_u32 s71, s65, 2
  s_and_b32 s71, s71, 7
  s_mul_i32 s73, s71, 196608
  s_add_u32 m0, s77, 155648
  s_nop 0
  buffer_load_dwordx4 v12, s[48:51], s73 offen lds
  ds_read_b64_tr_b16 v[216:217], v19 offset:24576
  ds_read_b64_tr_b16 v[218:219], v19 offset:25088
  s_waitcnt lgkmcnt(7)
  v_mfma_f32_32x32x16_bf16 v[164:179], v[228:231], v[132:135], v[164:179]
  s_lshl_b32 s95, s2, 3
  ds_read_b128 v[140:143], v16 offset:0
  s_add_u32 s95, s95, s60
  ds_read_b64_tr_b16 v[236:237], v20 offset:16384
  s_sub_u32 s66, s95, 1376
  s_cmp_lt_u32 s95, 1376
  s_cselect_b32 s95, s95, s66
  s_cselect_b64 s[52:53], s[18:19], s[10:11]
  ds_read_b64_tr_b16 v[238:239], v20 offset:16896
  s_waitcnt lgkmcnt(8)
  v_mfma_f32_32x32x16_bf16 v[180:195], v[232:235], v[132:135], v[180:195]
  s_mov_b32 s66, 524288
  s_cselect_b32 s54, 1409024, s66
  ds_read_b64_tr_b16 v[240:241], v20 offset:24576
  s_mov_b32 s55, 0x20000
  ds_read_b64_tr_b16 v[242:243], v20 offset:25088
  s_lshl_b32 s95, s95, 10
  s_waitcnt lgkmcnt(7)
  v_mfma_f32_32x32x16_bf16 v[164:179], v[212:215], v[136:139], v[164:179]
  ds_read_b128 v[144:147], v17 offset:0
  ds_read_b64_tr_b16 v[228:229], v21 offset:16384
  ds_read_b64_tr_b16 v[230:231], v21 offset:16896
  s_waitcnt lgkmcnt(8)
  v_mfma_f32_32x32x16_bf16 v[180:195], v[216:219], v[136:139], v[180:195]
  buffer_load_dwordx4 v[224:227], v1, s[52:55], s95 offen
  ds_read_b64_tr_b16 v[232:233], v21 offset:24576
  ds_read_b64_tr_b16 v[234:235], v21 offset:25088
  s_waitcnt vmcnt(3)
  s_barrier
  s_waitcnt lgkmcnt(7)
  v_mfma_f32_32x32x16_bf16 v[164:179], v[236:239], v[140:143], v[164:179]
  v_min_u32 v2, v197, v199
  ds_read_b128 v[148:151], v14 offset:32768
  v_min3_u32 v2, v2, v201, v203
  ds_read_b64_tr_b16 v[212:213], v18 offset:49152
  v_min3_u32 v2, v2, v205, v207
  v_min3_u32 v2, v2, v209, v211
  ds_read_b64_tr_b16 v[214:215], v18 offset:49664
  s_waitcnt lgkmcnt(8)
  v_mfma_f32_32x32x16_bf16 v[180:195], v[240:243], v[140:143], v[180:195]
  v_max_u32 v3, v197, v199
  v_max3_u32 v3, v3, v201, v203
  ds_read_b64_tr_b16 v[216:217], v18 offset:57344
  v_max3_u32 v3, v3, v205, v207
  ds_read_b64_tr_b16 v[218:219], v18 offset:57856
  v_max3_u32 v3, v3, v209, v211
  s_waitcnt lgkmcnt(7)
  v_mfma_f32_32x32x16_bf16 v[164:179], v[228:231], v[144:147], v[164:179]
  v_cmp_eq_u32 vcc, s90, v2
  ds_read_b128 v[152:155], v15 offset:32768
  v_cmp_eq_u32 s[96:97], s90, v3
  ds_read_b64_tr_b16 v[236:237], v19 offset:49152
  s_and_b64 vcc, vcc, s[96:97]
  ds_read_b64_tr_b16 v[238:239], v19 offset:49664
  s_waitcnt lgkmcnt(8)
  v_mfma_f32_32x32x16_bf16 v[180:195], v[232:235], v[144:147], v[180:195]
  s_cmp_eq_u64 vcc, -1
  s_cbranch_scc0 ALrare_67
ALback_68:
  ds_read_b64_tr_b16 v[240:241], v19 offset:57344
  s_cmp_lg_u32 s62, 1
  s_cbranch_scc1 ALskip_71
  v_add_f32 v196, v196, v200
  v_add_f32 v197, v198, v202
  v_add_f32 v204, v204, v208
  v_add_f32 v205, v206, v210
  v_pk_add_f32 v[196:197], v[196:197], v[204:205]
  s_nop 1
  v_permlane32_swap_b32 v196, v197
  v_add_f32 v196, v196, v197
  v_mov_b32 v197, v196
  s_nop 1
  v_permlane32_swap_b32 v196, v197
  v_mul_f32 v196, 0x3b000000, v196
  v_mul_f32 v197, 0x3b000000, v197
  v_fma_f32 v197, -v196, v196, v197
  v_cvt_pk_bf16_f32 v248, -v196, -v196
  v_max_f32 v197, 0, v197
  v_cvt_pk_bf16_f32 v2, v197, v197
  v_and_b32 v2, 0xffff0000, v2
  v_add_f32 v2, 0x3727c5ac, v2
  v_cvt_pk_bf16_f32 v2, v2, v2
  v_and_b32 v2, 0xffff0000, v2
  v_sqrt_f32 v2, v2
  s_nop 0
  v_cvt_pk_bf16_f32 v2, v2, v2
  v_and_b32 v249, 0xffff0000, v2
  v_rcp_f32 v34, v249
  v_and_b32 v5, 31, v0
  v_lshlrev_b32 v5, 3, v5
  s_lshl_b32 s66, s61, 8
  s_add_u32 s66, s66, 34816
  v_add_u32 v5, s66, v5
  ds_write_b64 v5, v[248:249]
ALskip_71:
  ds_read_b64_tr_b16 v[242:243], v19 offset:57856
  s_cmp_lg_u32 s62, 0
  s_cbranch_scc1 ALskip_72
  v_add_f32 v196, v196, v198
  v_add_f32 v200, v200, v202
  v_add_f32 v196, v196, v200
  v_cvt_pk_bf16_f32 v7, v196, v196
  v_and_b32 v7, 0xffff0000, v7
  v_sub_f32 v7, v196, v7
  v_cvt_pk_bf16_f32 v4, v196, v7
  v_add_f32 v204, v204, v206
  v_add_f32 v208, v208, v210
  v_add_f32 v204, v204, v208
  v_cvt_pk_bf16_f32 v7, v204, v204
  v_and_b32 v7, 0xffff0000, v7
  v_sub_f32 v7, v204, v7
  v_cvt_pk_bf16_f32 v6, v204, v7
  v_lshlrev_b32 v5, 2, v0
  s_lshl_b32 s66, s61, 8
  s_add_u32 s66, s66, 32768
  v_add_u32 v5, s66, v5
  ds_write_b32 v5, v4
  ds_write_b32 v5, v6 offset:1024
ALskip_72:
  s_waitcnt lgkmcnt(8)
  v_mfma_f32_32x32x16_bf16 v[164:179], v[212:215], v[148:151], v[164:179]
  ds_read_b128 v[156:159], v16 offset:32768
  ds_read_b64_tr_b16 v[228:229], v20 offset:49152
  ds_read_b64_tr_b16 v[230:231], v20 offset:49664
  s_waitcnt lgkmcnt(9)
  v_mfma_f32_32x32x16_bf16 v[180:195], v[216:219], v[148:151], v[180:195]
  ds_read_b64_tr_b16 v[232:233], v20 offset:57344
  ds_read_b64_tr_b16 v[234:235], v20 offset:57856
  s_waitcnt lgkmcnt(8)
  v_mfma_f32_32x32x16_bf16 v[164:179], v[236:239], v[152:155], v[164:179]
  ds_read_b128 v[160:163], v17 offset:32768
  ds_read_b64_tr_b16 v[212:213], v21 offset:49152
  ds_read_b64_tr_b16 v[214:215], v21 offset:49664
  s_waitcnt lgkmcnt(8)
  v_mfma_f32_32x32x16_bf16 v[180:195], v[240:243], v[152:155], v[180:195]
  ds_read_b64_tr_b16 v[216:217], v21 offset:57344
  ds_read_b64_tr_b16 v[218:219], v21 offset:57856
  s_waitcnt lgkmcnt(7)
  v_mfma_f32_32x32x16_bf16 v[164:179], v[228:231], v[156:159], v[164:179]
  s_waitcnt lgkmcnt(5)
  v_mfma_f32_32x32x16_bf16 v[180:195], v[232:235], v[156:159], v[180:195]
  s_waitcnt vmcnt(1) lgkmcnt(0)
  s_barrier
  v_mfma_f32_32x32x16_bf16 v[164:179], v[212:215], v[160:163], v[164:179]
  v_add_u32 v18, 65536, v18
  v_add_u32 v19, 65536, v19
  v_add_u32 v20, 65536, v20
  v_add_u32 v21, 65536, v21
  ds_read_b64_tr_b16 v[228:229], v18 offset:0
  ds_read_b64_tr_b16 v[230:231], v18 offset:512
  s_add_u32 s71, s65, 3
  s_and_b32 s71, s71, 7
  s_mul_i32 s73, s71, 196608
  s_add_u32 m0, s77, 0
  s_nop 0
  buffer_load_dwordx4 v12, s[48:51], s73 offen lds
  s_add_u32 s71, s65, 4
  s_and_b32 s71, s71, 7
  s_mul_i32 s73, s71, 196608
  s_add_u32 m0, s77, 8192
  s_nop 0
  buffer_load_dwordx4 v12, s[48:51], s73 offen lds
  v_mfma_f32_32x32x16_bf16 v[180:195], v[216:219], v[160:163], v[180:195]
  ds_read_b64_tr_b16 v[232:233], v19 offset:0
  ds_read_b64_tr_b16 v[234:235], v19 offset:512
  v_lshlrev_b32 v6, 2, v0
  s_lshl_b32 s66, s62, 9
  s_add_u32 s66, s66, 32768
  v_add_u32 v6, s66, v6
  ds_read_b32 v4, v6
  ds_read_b32 v5, v6 offset:256
  ds_read_b32 v28, v6 offset:1024
  ds_read_b32 v29, v6 offset:1280
  v_and_b32 v6, 31, v0
  v_lshlrev_b32 v6, 3, v6
  s_lshl_b32 s66, s61, 8
  s_add_u32 s66, s66, 34816
  v_add_u32 v6, s66, v6
  ds_read_b64 v[248:249], v6
  v_mov_b32 v250, 0
  v_mov_b32 v251, 0
  v_mov_b32 v253, 0
  v_mov_b32 v254, 0
  v_mov_b32 v255, 0
  s_waitcnt lgkmcnt(0)
  v_mov_b32 v35, v249
  v_rcp_f32 v34, v249
  v_mov_b32 v249, 0
  v_mov_b32 v252, v4
  s_nop 1
  v_mfma_f32_32x32x16_bf16 v[164:179], v[252:255], v[248:251], v[164:179]
  v_mov_b32 v252, v5
  s_nop 1
  v_mfma_f32_32x32x16_bf16 v[180:195], v[252:255], v[248:251], v[180:195]
  v_mul_f32 v26, 1069066811, v34
  v_mov_b32 v6, 0x3f803f80
  v_mov_b32 v7, 0x3f803f80
  s_add_u32 s71, s65, 5
  s_and_b32 s71, s71, 7
  s_mul_i32 s73, s71, 196608
  s_add_u32 m0, s77, 16384
  s_nop 0
  buffer_load_dwordx4 v12, s[48:51], s73 offen lds
  s_add_u32 s71, s65, 6
  s_and_b32 s71, s71, 7
  s_mul_i32 s73, s71, 196608
  s_add_u32 m0, s77, 24576
  s_nop 0
  buffer_load_dwordx4 v12, s[48:51], s73 offen lds
  v_cvt_pk_bf16_f32 v236, v164, v165
  v_cvt_pk_bf16_f32 v237, v166, v167
  v_cvt_pk_bf16_f32 v238, v168, v169
  v_cvt_pk_bf16_f32 v239, v170, v171
  v_cvt_pk_bf16_f32 v240, v172, v173
  v_cvt_pk_bf16_f32 v241, v174, v175
  v_cvt_pk_bf16_f32 v242, v176, v177
  v_cvt_pk_bf16_f32 v243, v178, v179
  v_mfma_f32_32x32x16_bf16 v[164:179], v[244:247], v[236:239], 0
  v_pk_mul_f32 v[180:181], v[180:181], v[34:35] op_sel_hi:[1,0]
  v_pk_mul_f32 v[182:183], v[182:183], v[34:35] op_sel_hi:[1,0]
  v_pk_mul_f32 v[184:185], v[184:185], v[34:35] op_sel_hi:[1,0]
  v_pk_mul_f32 v[186:187], v[186:187], v[34:35] op_sel_hi:[1,0]
  v_pk_mul_f32 v[188:189], v[188:189], v[34:35] op_sel_hi:[1,0]
  v_pk_mul_f32 v[190:191], v[190:191], v[34:35] op_sel_hi:[1,0]
  v_pk_mul_f32 v[192:193], v[192:193], v[34:35] op_sel_hi:[1,0]
  v_pk_mul_f32 v[194:195], v[194:195], v[34:35] op_sel_hi:[1,0]
  v_cvt_pk_bf16_f32 v180, v180, v181
  v_cvt_pk_bf16_f32 v181, v182, v183
  v_cvt_pk_bf16_f32 v182, v184, v185
  v_cvt_pk_bf16_f32 v183, v186, v187
  v_cvt_pk_bf16_f32 v184, v188, v189
  v_cvt_pk_bf16_f32 v185, v190, v191
  v_cvt_pk_bf16_f32 v186, v192, v193
  v_cvt_pk_bf16_f32 v187, v194, v195
  ds_write_b64 v30, v[180:181] offset:0
  ds_write_b64 v30, v[182:183] offset:16
  ds_write_b64 v30, v[184:185] offset:5120
  ds_write_b64 v30, v[186:187] offset:5136
  s_mov_b64 exec, 0xffffffff
  ds_write_b64 v30, v[6:7] offset:32
  ds_write_b64 v30, v[6:7] offset:5152
  s_mov_b64 exec, -1
  s_waitcnt lgkmcnt(2)
  v_mfma_f32_32x32x16_bf16 v[180:195], v[244:247], v[240:243], 0
  v_max3_f32 v2, v164, v165, v166
  s_nop 10
  v_max3_f32 v220, v188, v189, v190
  v_max3_f32 v3, -v164, -v165, -v166
  v_max3_f32 v221, -v188, -v189, -v190
  v_max3_f32 v4, v167, v168, v169
  v_max3_f32 v222, v191, v192, v193
  v_max3_f32 v6, -v167, -v168, -v169
  s_waitcnt vmcnt(4)
  v_max3_f32 v224, -v191, -v192, -v193
  v_max3_f32 v2, v2, v170, v171
  v_max3_f32 v220, v220, v194, v195
  v_max3_f32 v3, v3, -v170, -v171
  v_max3_f32 v221, v221, -v194, -v195
  v_max_f32 v2, v2, v4
  v_max_f32 v220, v220, v222
  v_max_f32 v3, v3, v6
  v_max_f32 v221, v221, v224
  s_nop 0
  v_permlane32_swap_b32 v2, v3
  v_permlane32_swap_b32 v220, v221
  v_max_f32 v4, v2, v3
  v_max_f32 v222, v220, v221
  v_mul_f32 v4, v26, v4
  v_mul_f32 v222, v26, v222
  v_mov_b32 v6, v4
  v_mov_b32 v224, v222
  s_nop 0
  v_permlane32_swap_b32 v4, v6
  v_permlane32_swap_b32 v222, v224
  v_pk_fma_f32 v[172:173], v[164:165], v[26:27], v[6:7] op_sel_hi:[1,0,0] neg_lo:[1,0,1] neg_hi:[1,0,1]
  v_pk_fma_f32 v[180:181], v[188:189], v[26:27], v[224:225] op_sel_hi:[1,0,0] neg_lo:[1,0,1] neg_hi:[1,0,1]
  v_pk_fma_f32 v[164:165], v[164:165], v[26:27], v[4:5] op_sel_hi:[1,0,0] neg_lo:[0,0,1] neg_hi:[0,0,1]
  v_pk_fma_f32 v[188:189], v[188:189], v[26:27], v[222:223] op_sel_hi:[1,0,0] neg_lo:[0,0,1] neg_hi:[0,0,1]
  s_add_u32 s71, s65, 7
  s_and_b32 s71, s71, 7
  s_mul_i32 s73, s71, 196608
  s_add_u32 m0, s77, 98304
  s_nop 0
  buffer_load_dwordx4 v12, s[48:51], s73 offen lds
  s_add_u32 s71, s65, 1
  s_and_b32 s71, s71, 7
  s_mul_i32 s85, s71, 176128
  s_add_u32 m0, s77, 106496
  s_nop 0
  buffer_load_dwordx4 v13, s[44:47], s85 offen lds
  v_pk_fma_f32 v[174:175], v[166:167], v[26:27], v[6:7] op_sel_hi:[1,0,0] neg_lo:[1,0,1] neg_hi:[1,0,1]
  v_pk_fma_f32 v[182:183], v[190:191], v[26:27], v[224:225] op_sel_hi:[1,0,0] neg_lo:[1,0,1] neg_hi:[1,0,1]
  v_pk_fma_f32 v[166:167], v[166:167], v[26:27], v[4:5] op_sel_hi:[1,0,0] neg_lo:[0,0,1] neg_hi:[0,0,1]
  v_pk_fma_f32 v[190:191], v[190:191], v[26:27], v[222:223] op_sel_hi:[1,0,0] neg_lo:[0,0,1] neg_hi:[0,0,1]
  v_pk_fma_f32 v[176:177], v[168:169], v[26:27], v[6:7] op_sel_hi:[1,0,0] neg_lo:[1,0,1] neg_hi:[1,0,1]
  v_pk_fma_f32 v[184:185], v[192:193], v[26:27], v[224:225] op_sel_hi:[1,0,0] neg_lo:[1,0,1] neg_hi:[1,0,1]
  v_pk_fma_f32 v[168:169], v[168:169], v[26:27], v[4:5] op_sel_hi:[1,0,0] neg_lo:[0,0,1] neg_hi:[0,0,1]
  v_pk_fma_f32 v[192:193], v[192:193], v[26:27], v[222:223] op_sel_hi:[1,0,0] neg_lo:[0,0,1] neg_hi:[0,0,1]
  v_pk_fma_f32 v[178:179], v[170:171], v[26:27], v[6:7] op_sel_hi:[1,0,0] neg_lo:[1,0,1] neg_hi:[1,0,1]
  v_pk_fma_f32 v[186:187], v[194:195], v[26:27], v[224:225] op_sel_hi:[1,0,0] neg_lo:[1,0,1] neg_hi:[1,0,1]
  v_pk_fma_f32 v[170:171], v[170:171], v[26:27], v[4:5] op_sel_hi:[1,0,0] neg_lo:[0,0,1] neg_hi:[0,0,1]
  v_pk_fma_f32 v[194:195], v[194:195], v[26:27], v[222:223] op_sel_hi:[1,0,0] neg_lo:[0,0,1] neg_hi:[0,0,1]
  v_exp_f32 v172, v172
  v_exp_f32 v180, v180
  v_exp_f32 v164, v164
  v_exp_f32 v188, v188
  v_exp_f32 v173, v173
  v_exp_f32 v181, v181
  v_exp_f32 v165, v165
  v_exp_f32 v189, v189
  v_exp_f32 v174, v174
  v_exp_f32 v182, v182
  v_exp_f32 v166, v166
  v_exp_f32 v190, v190
  v_exp_f32 v175, v175
  v_exp_f32 v183, v183
  v_exp_f32 v167, v167
  v_exp_f32 v191, v191
  v_exp_f32 v176, v176
  v_exp_f32 v184, v184
  v_exp_f32 v168, v168
  v_exp_f32 v192, v192
  s_add_u32 s71, s65, 2
  s_and_b32 s71, s71, 7
  s_mul_i32 s85, s71, 176128
  s_add_u32 m0, s77, 114688
  s_nop 0
  buffer_load_dwordx4 v13, s[44:47], s85 offen lds
  s_add_u32 s71, s65, 3
  s_and_b32 s71, s71, 7
  s_mul_i32 s85, s71, 176128
  s_add_u32 m0, s77, 122880
  s_nop 0
  buffer_load_dwordx4 v13, s[44:47], s85 offen lds
  v_exp_f32 v177, v177
  v_exp_f32 v185, v185
  v_exp_f32 v169, v169
  v_exp_f32 v193, v193
  v_exp_f32 v178, v178
  v_exp_f32 v186, v186
  v_exp_f32 v170, v170
  v_exp_f32 v194, v194
  v_exp_f32 v179, v179
  v_exp_f32 v187, v187
  v_exp_f32 v171, v171
  v_exp_f32 v195, v195
  v_pk_add_f32 v[4:5], v[164:165], v[166:167]
  v_pk_add_f32 v[222:223], v[188:189], v[190:191]
  v_pk_add_f32 v[6:7], v[172:173], v[174:175]
  v_pk_add_f32 v[224:225], v[180:181], v[182:183]
  v_pk_add_f32 v[2:3], v[168:169], v[170:171]
  v_pk_add_f32 v[220:221], v[192:193], v[194:195]
  v_pk_add_f32 v[6:7], v[6:7], v[176:177]
  v_pk_add_f32 v[224:225], v[224:225], v[184:185]
  v_pk_add_f32 v[4:5], v[4:5], v[2:3]
  v_pk_add_f32 v[222:223], v[222:223], v[220:221]
  v_pk_add_f32 v[6:7], v[6:7], v[178:179]
  v_pk_add_f32 v[224:225], v[224:225], v[186:187]
  v_add_f32 v2, v4, v5
  v_add_f32 v220, v222, v223
  v_add_f32 v3, v6, v7
  v_add_f32 v221, v224, v225
  s_nop 0
  v_permlane32_swap_b32 v2, v3
  v_permlane32_swap_b32 v220, v221
  v_add_f32 v4, v2, v3
  v_add_f32 v222, v220, v221
  v_rcp_f32 v4, v4
  v_rcp_f32 v222, v222
  v_mov_b32 v6, v4
  v_mov_b32 v224, v222
  s_nop 0
  v_permlane32_swap_b32 v4, v6
  v_permlane32_swap_b32 v222, v224
  v_pk_mul_f32 v[164:165], v[164:165], v[4:5] op_sel_hi:[1,0]
  v_pk_mul_f32 v[188:189], v[188:189], v[222:223] op_sel_hi:[1,0]
  v_pk_mul_f32 v[172:173], v[172:173], v[6:7] op_sel_hi:[1,0]
  v_pk_mul_f32 v[180:181], v[180:181], v[224:225] op_sel_hi:[1,0]
  v_pk_mul_f32 v[166:167], v[166:167], v[4:5] op_sel_hi:[1,0]
  v_pk_mul_f32 v[190:191], v[190:191], v[222:223] op_sel_hi:[1,0]
  v_pk_mul_f32 v[174:175], v[174:175], v[6:7] op_sel_hi:[1,0]
  v_pk_mul_f32 v[182:183], v[182:183], v[224:225] op_sel_hi:[1,0]
  v_pk_mul_f32 v[168:169], v[168:169], v[4:5] op_sel_hi:[1,0]
  v_pk_mul_f32 v[192:193], v[192:193], v[222:223] op_sel_hi:[1,0]
  v_pk_mul_f32 v[176:177], v[176:177], v[6:7] op_sel_hi:[1,0]
  v_pk_mul_f32 v[184:185], v[184:185], v[224:225] op_sel_hi:[1,0]
  v_pk_mul_f32 v[170:171], v[170:171], v[4:5] op_sel_hi:[1,0]
  v_pk_mul_f32 v[194:195], v[194:195], v[222:223] op_sel_hi:[1,0]
  v_pk_mul_f32 v[178:179], v[178:179], v[6:7] op_sel_hi:[1,0]
  v_pk_mul_f32 v[186:187], v[186:187], v[224:225] op_sel_hi:[1,0]
  v_cvt_pk_bf16_f32 v164, v164, v165
  v_cvt_pk_bf16_f32 v188, v188, v189
  v_cvt_pk_bf16_f32 v172, v172, v173
  v_cvt_pk_bf16_f32 v180, v180, v181
  v_cvt_pk_bf16_f32 v165, v166, v167
  v_cvt_pk_bf16_f32 v189, v190, v191
  v_cvt_pk_bf16_f32 v173, v174, v175
  v_cvt_pk_bf16_f32 v181, v182, v183
  v_cvt_pk_bf16_f32 v166, v168, v169
  v_cvt_pk_bf16_f32 v190, v192, v193
  v_cvt_pk_bf16_f32 v174, v176, v177
  v_cvt_pk_bf16_f32 v182, v184, v185
  v_cvt_pk_bf16_f32 v167, v170, v171
  v_cvt_pk_bf16_f32 v191, v194, v195
  v_cvt_pk_bf16_f32 v175, v178, v179
  v_cvt_pk_bf16_f32 v183, v186, v187
  v_xor_b32 v2, 32, v31
  v_xor_b32 v3, 32, v33
  ds_write_b64 v31, v[164:165] offset:0
  ds_write_b64 v33, v[166:167] offset:0
  ds_write_b64 v2, v[172:173] offset:0
  ds_write_b64 v3, v[174:175] offset:0
  ds_write_b64 v31, v[188:189] offset:8192
  ds_write_b64 v33, v[190:191] offset:8192
  ds_write_b64 v2, v[180:181] offset:8192
  ds_write_b64 v3, v[182:183] offset:8192
  s_cmp_lg_u32 s62, 0
  s_cbranch_scc1 ALskip_73
  v_mfma_f32_32x32x16_bf16 v[196:211], v[228:231], v[36:39], 0
  v_lshrrev_b32 v2, 5, v0
  ds_read_b64_tr_b16 v[236:237], v20 offset:0
  v_bfe_u32 v3, v0, 2, 2
  ds_read_b64_tr_b16 v[238:239], v20 offset:512
  v_lshl_add_u32 v4, v2, 2, v3
  v_bfe_u32 v5, v0, 3, 1
  ds_read_b64_tr_b16 v[240:241], v21 offset:0
  v_lshl_add_u32 v2, v2, 1, v5
  ds_read_b64_tr_b16 v[242:243], v21 offset:512
  v_and_b32 v3, 3, v0
  v_mfma_f32_32x32x16_bf16 v[196:211], v[232:235], v[40:43], v[196:211]
  v_bfe_u32 v5, v0, 4, 1
  ds_read_b64_tr_b16 v[228:229], v18 offset:16384
  v_lshl_add_u32 v30, v5, 2, v3
  v_xor_b32 v2, v2, v30
  v_lshlrev_b32 v2, 3, v2
  ds_read_b64_tr_b16 v[230:231], v18 offset:16896
  v_lshl_add_u32 v2, v4, 6, v2
  s_lshl_b32 s66, s61, 13
  s_waitcnt lgkmcnt(4)
  v_mfma_f32_32x32x16_bf16 v[196:211], v[236:239], v[44:47], v[196:211]
  s_add_u32 s66, s66, 40960
  ds_read_b64_tr_b16 v[232:233], v19 offset:16384
  v_add_u32 v30, s66, v2
  v_xor_b32 v31, 32, v30
  v_mul_u32_u24 v4, 40, v4
  ds_read_b64_tr_b16 v[234:235], v19 offset:16896
  v_lshlrev_b32 v3, 3, v3
  v_cmp_eq_u32 vcc, 0, v5
  s_waitcnt lgkmcnt(4)
  v_mfma_f32_32x32x16_bf16 v[196:211], v[240:243], v[48:51], v[196:211]
  v_cndmask_b32 v3, 32, v3, vcc
  ds_read_b64_tr_b16 v[236:237], v20 offset:16384
  v_add_u32 v4, v4, v3
  s_mul_i32 s66, s61, 5120
  s_add_u32 s66, s66, 73728
  ds_read_b64_tr_b16 v[238:239], v20 offset:16896
  v_add_u32 v32, s66, v4
  s_lshl_b32 s82, s64, 4
  s_waitcnt lgkmcnt(4)
  v_mfma_f32_32x32x16_bf16 v[196:211], v[228:231], v[52:55], v[196:211]
  s_add_u32 s82, s82, s63
  ds_read_b64_tr_b16 v[240:241], v21 offset:16384
  s_lshl_b32 s82, s82, 2
  s_add_u32 s82, s82, s61
  s_lshl_b32 s82, s82, 13
  ds_read_b64_tr_b16 v[242:243], v21 offset:16896
  s_add_u32 s82, s82, 8388608
  s_waitcnt lgkmcnt(4)
  v_mfma_f32_32x32x16_bf16 v[196:211], v[232:235], v[56:59], v[196:211]
  ds_read_b64_tr_b16 v[228:229], v18 offset:24576
  ds_read_b64_tr_b16 v[230:231], v18 offset:25088
  s_waitcnt lgkmcnt(4)
  v_mfma_f32_32x32x16_bf16 v[196:211], v[236:239], v[60:63], v[196:211]
  ds_read_b64_tr_b16 v[232:233], v19 offset:24576
  ds_read_b64_tr_b16 v[234:235], v19 offset:25088
  s_waitcnt lgkmcnt(4)
  v_mfma_f32_32x32x16_bf16 v[196:211], v[240:243], v[64:67], v[196:211]
  ds_read_b64_tr_b16 v[236:237], v20 offset:24576
  ds_read_b64_tr_b16 v[238:239], v20 offset:25088
ALskip_73:
  s_waitcnt vmcnt(0) lgkmcnt(0)
  s_barrier
  s_cmp_lg_u32 s62, 0
  s_cbranch_scc1 ALelse_74
  ds_read_b64_tr_b16 v[180:181], v30 offset:0
  ds_read_b64_tr_b16 v[182:183], v31 offset:512
  ds_read_b64_tr_b16 v[184:185], v32 offset:0
  ds_read_b64_tr_b16 v[186:187], v32 offset:320
  ds_read_b64_tr_b16 v[188:189], v30 offset:1024
  ds_read_b64_tr_b16 v[190:191], v31 offset:1536
  ds_read_b64_tr_b16 v[192:193], v32 offset:640
  ds_read_b64_tr_b16 v[194:195], v32 offset:960
  ds_read_b64_tr_b16 v[212:213], v30 offset:2048
  ds_read_b64_tr_b16 v[214:215], v31 offset:2560
  ds_read_b64_tr_b16 v[216:217], v32 offset:1280
  ds_read_b64_tr_b16 v[218:219], v32 offset:1600
  ds_read_b64_tr_b16 v[220:221], v30 offset:3072
  ds_read_b64_tr_b16 v[222:223], v31 offset:3584
  ds_read_b64_tr_b16 v[224:225], v32 offset:1920
  ds_read_b64_tr_b16 v[226:227], v32 offset:2240
  s_waitcnt lgkmcnt(12)
  v_mfma_f32_32x32x16_bf16 v[164:179], v[180:183], v[184:187], 0
  ds_read_b64_tr_b16 v[180:181], v30 offset:4096
  ds_read_b64_tr_b16 v[182:183], v31 offset:4608
  ds_read_b64_tr_b16 v[184:185], v32 offset:2560
  ds_read_b64_tr_b16 v[186:187], v32 offset:2880
  s_waitcnt lgkmcnt(12)
  v_mfma_f32_32x32x16_bf16 v[164:179], v[188:191], v[192:195], v[164:179]
  ds_read_b64_tr_b16 v[188:189], v30 offset:5120
  ds_read_b64_tr_b16 v[190:191], v31 offset:5632
  ds_read_b64_tr_b16 v[192:193], v32 offset:3200
  ds_read_b64_tr_b16 v[194:195], v32 offset:3520
  s_waitcnt lgkmcnt(12)
  v_mfma_f32_32x32x16_bf16 v[164:179], v[212:215], v[216:219], v[164:179]
  ds_read_b64_tr_b16 v[212:213], v30 offset:6144
  ds_read_b64_tr_b16 v[214:215], v31 offset:6656
  ds_read_b64_tr_b16 v[216:217], v32 offset:3840
  ds_read_b64_tr_b16 v[218:219], v32 offset:4160
  s_waitcnt lgkmcnt(12)
  v_mfma_f32_32x32x16_bf16 v[164:179], v[220:223], v[224:227], v[164:179]
  ds_read_b64_tr_b16 v[220:221], v30 offset:7168
  ds_read_b64_tr_b16 v[222:223], v31 offset:7680
  ds_read_b64_tr_b16 v[224:225], v32 offset:4480
  ds_read_b64_tr_b16 v[226:227], v32 offset:4800
  s_waitcnt lgkmcnt(12)
  v_mfma_f32_32x32x16_bf16 v[164:179], v[180:183], v[184:187], v[164:179]
  s_waitcnt lgkmcnt(8)
  v_mfma_f32_32x32x16_bf16 v[164:179], v[188:191], v[192:195], v[164:179]
  s_waitcnt lgkmcnt(4)
  v_mfma_f32_32x32x16_bf16 v[164:179], v[212:215], v[216:219], v[164:179]
  s_waitcnt lgkmcnt(0)
  v_mfma_f32_32x32x16_bf16 v[164:179], v[220:223], v[224:227], v[164:179]
  v_mov_b32 v181, s90
  v_mov_b32 v183, s90
  v_mov_b32 v185, s90
  v_mov_b32 v187, s90
  v_mov_b32 v189, s90
  v_mov_b32 v191, s90
  v_mov_b32 v193, s90
  v_mov_b32 v195, s90
  s_nop 3
  v_mov_b32 v180, v164
  v_mov_b32 v182, v165
  buffer_store_dwordx4 v[180:183], v1, s[28:31], s82 offen offset:0 sc1
  v_mov_b32 v184, v166
  v_mov_b32 v186, v167
  buffer_store_dwordx4 v[184:187], v1, s[28:31], s82 offen offset:1024 sc1
  v_mov_b32 v188, v168
  v_mov_b32 v190, v169
  buffer_store_dwordx4 v[188:191], v1, s[28:31], s82 offen offset:2048 sc1
  v_mov_b32 v192, v170
  v_mov_b32 v194, v171
  buffer_store_dwordx4 v[192:195], v1, s[28:31], s82 offen offset:3072 sc1
  v_mov_b32 v180, v172
  v_mov_b32 v182, v173
  s_add_u32 s82, s82, 4096
  buffer_store_dwordx4 v[180:183], v1, s[28:31], s82 offen offset:0 sc1
  v_mov_b32 v184, v174
  v_mov_b32 v186, v175
  buffer_store_dwordx4 v[184:187], v1, s[28:31], s82 offen offset:1024 sc1
  v_mov_b32 v188, v176
  v_mov_b32 v190, v177
  buffer_store_dwordx4 v[188:191], v1, s[28:31], s82 offen offset:2048 sc1
  v_mov_b32 v192, v178
  v_mov_b32 v194, v179
  buffer_store_dwordx4 v[192:195], v1, s[28:31], s82 offen offset:3072 sc1
  s_branch ALend_75
ALelse_74:
  v_mfma_f32_32x32x16_bf16 v[196:211], v[228:231], v[36:39], 0
  ds_read_b64_tr_b16 v[236:237], v20 offset:0
  ds_read_b64_tr_b16 v[238:239], v20 offset:512
  ds_read_b64_tr_b16 v[240:241], v21 offset:0
  ds_read_b64_tr_b16 v[242:243], v21 offset:512
  v_mfma_f32_32x32x16_bf16 v[196:211], v[232:235], v[40:43], v[196:211]
  ds_read_b64_tr_b16 v[228:229], v18 offset:16384
  ds_read_b64_tr_b16 v[230:231], v18 offset:16896
  s_waitcnt lgkmcnt(4)
  v_mfma_f32_32x32x16_bf16 v[196:211], v[236:239], v[44:47], v[196:211]
  ds_read_b64_tr_b16 v[232:233], v19 offset:16384
  ds_read_b64_tr_b16 v[234:235], v19 offset:16896
  s_waitcnt lgkmcnt(4)
  v_mfma_f32_32x32x16_bf16 v[196:211], v[240:243], v[48:51], v[196:211]
  ds_read_b64_tr_b16 v[236:237], v20 offset:16384
  ds_read_b64_tr_b16 v[238:239], v20 offset:16896
  s_waitcnt lgkmcnt(4)
  v_mfma_f32_32x32x16_bf16 v[196:211], v[228:231], v[52:55], v[196:211]
  ds_read_b64_tr_b16 v[240:241], v21 offset:16384
  ds_read_b64_tr_b16 v[242:243], v21 offset:16896
  s_waitcnt lgkmcnt(4)
  v_mfma_f32_32x32x16_bf16 v[196:211], v[232:235], v[56:59], v[196:211]
  ds_read_b64_tr_b16 v[228:229], v18 offset:24576
  ds_read_b64_tr_b16 v[230:231], v18 offset:25088
  s_waitcnt lgkmcnt(4)
  v_mfma_f32_32x32x16_bf16 v[196:211], v[236:239], v[60:63], v[196:211]
  ds_read_b64_tr_b16 v[232:233], v19 offset:24576
  ds_read_b64_tr_b16 v[234:235], v19 offset:25088
  s_waitcnt lgkmcnt(4)
  v_mfma_f32_32x32x16_bf16 v[196:211], v[240:243], v[64:67], v[196:211]
  ds_read_b64_tr_b16 v[236:237], v20 offset:24576
  ds_read_b64_tr_b16 v[238:239], v20 offset:25088
ALend_75:
  s_waitcnt lgkmcnt(4)
  v_mfma_f32_32x32x16_bf16 v[196:211], v[228:231], v[68:71], v[196:211]
  ds_read_b64_tr_b16 v[240:241], v21 offset:24576
  ds_read_b64_tr_b16 v[242:243], v21 offset:25088
  s_waitcnt lgkmcnt(4)
  v_mfma_f32_32x32x16_bf16 v[196:211], v[232:235], v[72:75], v[196:211]
  v_add_u32 v18, 4294836224, v18
  v_add_u32 v19, 4294836224, v19
  v_add_u32 v20, 4294836224, v20
  v_add_u32 v21, 4294836224, v21
  ds_read_b64_tr_b16 v[228:229], v18 offset:0
  ds_read_b64_tr_b16 v[230:231], v18 offset:512
  s_waitcnt lgkmcnt(4)
  v_mfma_f32_32x32x16_bf16 v[196:211], v[236:239], v[76:79], v[196:211]
  ds_read_b64_tr_b16 v[232:233], v19 offset:0
  s_mov_b32 exec_lo, 0xffff
  s_mov_b32 exec_hi, 0xffff
  v_mov_b32 v30, 0
  v_mov_b32 v31, 0
  v_mov_b32 v32, 0
  v_mov_b32 v33, 0
  s_not_b64 exec, exec
  v_mov_b32 v30, v244
  v_mov_b32 v244, 0
  v_mov_b32 v31, v245
  v_mov_b32 v245, 0
  v_mov_b32 v32, v246
  v_mov_b32 v246, 0
  v_mov_b32 v33, v247
  v_mov_b32 v247, 0
  s_mov_b64 exec, -1
  ds_read_b64_tr_b16 v[234:235], v19 offset:512
  s_waitcnt lgkmcnt(4)
  v_mfma_f32_32x32x16_bf16 v[196:211], v[240:243], v[80:83], v[196:211]
  ds_read_b64_tr_b16 v[236:237], v20 offset:0
  ds_read_b64_tr_b16 v[238:239], v20 offset:512
  s_waitcnt lgkmcnt(4)
  v_mfma_f32_32x32x16_bf16 v[196:211], v[228:231], v[84:87], v[196:211]
  ds_read_b64_tr_b16 v[240:241], v21 offset:0
  ds_read_b64_tr_b16 v[242:243], v21 offset:512
  s_waitcnt lgkmcnt(4)
  v_mfma_f32_32x32x16_bf16 v[196:211], v[232:235], v[88:91], v[196:211]
  ds_read_b64_tr_b16 v[228:229], v18 offset:8192
  ds_read_b64_tr_b16 v[230:231], v18 offset:8704
  s_waitcnt lgkmcnt(4)
  v_mfma_f32_32x32x16_bf16 v[196:211], v[236:239], v[92:95], v[196:211]
  s_bfe_u32 s26, s2, 0x30003
  ds_read_b64_tr_b16 v[232:233], v19 offset:8192
  s_mov_b32 s67, s70
  s_lshl_b32 s3, s70, 1
  s_add_u32 s3, s3, s26
  ds_read_b64_tr_b16 v[234:235], v19 offset:8704
  s_and_b32 s27, s2, 1
  s_lshl_b32 s27, s27, 4
  s_waitcnt lgkmcnt(4)
  v_mfma_f32_32x32x16_bf16 v[196:211], v[240:243], v[96:99], v[196:211]
  s_and_b32 s66, s2, 6
  ds_read_b64_tr_b16 v[236:237], v20 offset:8192
  s_lshl_b32 s66, s66, 1
  s_add_u32 s27, s27, s66
  s_add_u32 s27, s27, s67
  ds_read_b64_tr_b16 v[238:239], v20 offset:8704
  v_lshrrev_b32 v2, 3, v0
  v_lshlrev_b32 v2, 10, v2
  s_waitcnt lgkmcnt(4)
  v_mfma_f32_32x32x16_bf16 v[196:211], v[228:231], v[100:103], v[196:211]
  v_and_b32 v3, 7, v0
  ds_read_b64_tr_b16 v[240:241], v21 offset:8192
  v_bfe_u32 v4, v0, 4, 1
  v_lshlrev_b32 v4, 2, v4
  v_xor_b32 v3, v3, v4
  ds_read_b64_tr_b16 v[242:243], v21 offset:8704
  v_lshl_add_u32 v10, v3, 4, v2
  s_lshl_b32 s66, s26, 7
  s_waitcnt lgkmcnt(4)
  v_mfma_f32_32x32x16_bf16 v[196:211], v[232:235], v[104:107], v[196:211]
  v_add_u32 v10, s66, v10
  ds_read_b64_tr_b16 v[228:229], v18 offset:16384
  v_add_u32 v11, 7168, v10
  s_mov_b32 s36, s18
  s_mov_b32 s37, s19
  ds_read_b64_tr_b16 v[230:231], v18 offset:16896
  s_mov_b32 s38, 1409024
  s_mov_b32 s39, 0x20000
  s_barrier
  s_waitcnt lgkmcnt(4)
  v_mfma_f32_32x32x16_bf16 v[196:211], v[236:239], v[108:111], v[196:211]
  ds_read_b64_tr_b16 v[232:233], v19 offset:16384
  s_add_u32 s71, s65, 4
  s_and_b32 s71, s71, 7
  s_mul_i32 s85, s71, 176128
  s_add_u32 m0, s77, 49152
  s_nop 0
  buffer_load_dwordx4 v13, s[44:47], s85 offen lds
  s_add_u32 s71, s65, 5
  s_and_b32 s71, s71, 7
  s_mul_i32 s85, s71, 176128
  s_add_u32 m0, s77, 57344
  s_nop 0
  buffer_load_dwordx4 v13, s[44:47], s85 offen lds
  ds_read_b64_tr_b16 v[234:235], v19 offset:16896
  s_waitcnt lgkmcnt(4)
  v_mfma_f32_32x32x16_bf16 v[196:211], v[240:243], v[112:115], v[196:211]
  ds_read_b64_tr_b16 v[236:237], v20 offset:16384
  ds_read_b64_tr_b16 v[238:239], v20 offset:16896
  s_waitcnt lgkmcnt(4)
  v_mfma_f32_32x32x16_bf16 v[196:211], v[228:231], v[116:119], v[196:211]
  ds_read_b64_tr_b16 v[240:241], v21 offset:16384
  ds_read_b64_tr_b16 v[242:243], v21 offset:16896
  s_waitcnt lgkmcnt(4)
  v_mfma_f32_32x32x16_bf16 v[196:211], v[232:235], v[120:123], v[196:211]
  ds_read_b64_tr_b16 v[228:229], v18 offset:24576
  ds_read_b64_tr_b16 v[230:231], v18 offset:25088
  s_waitcnt lgkmcnt(4)
  v_mfma_f32_32x32x16_bf16 v[196:211], v[236:239], v[124:127], v[196:211]
  ds_read_b64_tr_b16 v[232:233], v19 offset:24576
  ds_read_b64_tr_b16 v[234:235], v19 offset:25088
  s_waitcnt lgkmcnt(4)
  v_mfma_f32_32x32x16_bf16 v[196:211], v[240:243], v[128:131], v[196:211]
  ds_read_b64_tr_b16 v[236:237], v20 offset:24576
  ds_read_b64_tr_b16 v[238:239], v20 offset:25088
  s_waitcnt lgkmcnt(4)
  v_mfma_f32_32x32x16_bf16 v[196:211], v[228:231], v[132:135], v[196:211]
  s_lshl_b32 s82, s64, 3
  ds_read_b64_tr_b16 v[240:241], v21 offset:24576
  s_add_u32 s82, s82, s60
  s_lshl_b32 s82, s82, 5
  s_add_u32 s82, s82, s63
  ds_read_b64_tr_b16 v[242:243], v21 offset:25088
  s_lshl_b32 s82, s82, 11
  s_add_u32 s82, s82, 8388608
  s_waitcnt lgkmcnt(4)
  v_mfma_f32_32x32x16_bf16 v[196:211], v[232:235], v[136:139], v[196:211]
  s_add_u32 s66, s82, 0
  v_add_u32 v18, 65536, v18
  v_add_u32 v19, 65536, v19
  v_add_u32 v20, 65536, v20
  v_add_u32 v21, 65536, v21
  ds_read_b64_tr_b16 v[228:229], v18 offset:32768
  buffer_load_dwordx4 v[164:167], v1, s[28:31], s66 offen offset:0 sc1
  buffer_load_dwordx4 v[168:171], v1, s[28:31], s66 offen offset:1024 sc1
  s_add_u32 s66, s82, 32768
  ds_read_b64_tr_b16 v[230:231], v18 offset:33280
  buffer_load_dwordx4 v[172:175], v1, s[28:31], s66 offen offset:0 sc1
  buffer_load_dwordx4 v[176:179], v1, s[28:31], s66 offen offset:1024 sc1
  s_waitcnt lgkmcnt(4)
  v_mfma_f32_32x32x16_bf16 v[196:211], v[236:239], v[140:143], v[196:211]
  ds_read_b64_tr_b16 v[232:233], v19 offset:32768
  ds_read_b64_tr_b16 v[234:235], v19 offset:33280
  s_waitcnt lgkmcnt(4)
  v_mfma_f32_32x32x16_bf16 v[196:211], v[240:243], v[144:147], v[196:211]
  ds_read_b64_tr_b16 v[236:237], v20 offset:32768
  ds_read_b64_tr_b16 v[238:239], v20 offset:33280
  s_waitcnt lgkmcnt(4)
  v_mfma_f32_32x32x16_bf16 v[196:211], v[228:231], v[148:151], v[196:211]
  ds_read_b64_tr_b16 v[240:241], v21 offset:32768
  ds_read_b64_tr_b16 v[242:243], v21 offset:33280
  s_waitcnt lgkmcnt(4)
  v_mfma_f32_32x32x16_bf16 v[196:211], v[232:235], v[152:155], v[196:211]
  v_add_u32 v22, 131072, v22
  v_add_u32 v23, 131072, v23
  v_add_u32 v24, 131072, v24
  v_add_u32 v25, 131072, v25
  ds_read_b64_tr_b16 v[228:229], v22 offset:8192
  ds_read_b64_tr_b16 v[230:231], v22 offset:8448
  s_waitcnt lgkmcnt(4)
  v_mfma_f32_32x32x16_bf16 v[196:211], v[236:239], v[156:159], v[196:211]
  ds_read_b64_tr_b16 v[232:233], v23 offset:8192
  ds_read_b64_tr_b16 v[234:235], v23 offset:8448
  s_waitcnt lgkmcnt(4)
  v_mfma_f32_32x32x16_bf16 v[196:211], v[240:243], v[160:163], v[196:211]
  ds_read_b64_tr_b16 v[236:237], v24 offset:8192
  ds_read_b64_tr_b16 v[238:239], v24 offset:8448
  s_waitcnt lgkmcnt(4)
  v_mfma_f32_32x32x16_bf16 v[212:227], v[228:231], v[36:39], 0
  ds_read_b64_tr_b16 v[240:241], v25 offset:8192
  ds_read_b64_tr_b16 v[242:243], v25 offset:8448
  s_waitcnt lgkmcnt(4)
  v_mfma_f32_32x32x16_bf16 v[212:227], v[232:235], v[40:43], v[212:227]
  v_add_u32 v22, 4294901760, v22
  v_add_u32 v23, 4294901760, v23
  v_add_u32 v24, 4294901760, v24
  v_add_u32 v25, 4294901760, v25
  ds_read_b64_tr_b16 v[228:229], v22 offset:40960
  ds_read_b64_tr_b16 v[230:231], v22 offset:41216
  s_waitcnt lgkmcnt(4)
  v_mfma_f32_32x32x16_bf16 v[212:227], v[236:239], v[44:47], v[212:227]
  s_waitcnt vmcnt(3)
  v_min_u32 v2, v165, v167
  ds_read_b64_tr_b16 v[232:233], v23 offset:40960
  s_waitcnt vmcnt(2)
  v_min3_u32 v2, v2, v169, v171
  s_waitcnt vmcnt(1)
  v_min3_u32 v2, v2, v173, v175
  s_waitcnt vmcnt(0)
  v_min3_u32 v2, v2, v177, v179
  ds_read_b64_tr_b16 v[234:235], v23 offset:41216
  v_max_u32 v3, v165, v167
  v_max3_u32 v3, v3, v169, v171
  s_waitcnt lgkmcnt(4)
  v_mfma_f32_32x32x16_bf16 v[212:227], v[240:243], v[48:51], v[212:227]
  v_max3_u32 v3, v3, v173, v175
  ds_read_b64_tr_b16 v[236:237], v24 offset:40960
  v_max3_u32 v3, v3, v177, v179
  v_cmp_eq_u32 vcc, s90, v2
  v_cmp_eq_u32 s[96:97], s90, v3
  ds_read_b64_tr_b16 v[238:239], v24 offset:41216
  s_and_b64 vcc, vcc, s[96:97]
  s_cmp_eq_u64 vcc, -1
  s_cbranch_scc0 ALrare_76
ALback_77:
  v_add_f32 v164, v164, v172
  v_add_f32 v165, v166, v174
  v_add_f32 v166, v168, v176
  v_add_f32 v167, v170, v178
  s_lshl_b32 s66, s60, 10
  s_add_u32 s66, s66, 36864
  v_add_u32 v5, s66, v1
  ds_write_b128 v5, v[164:167]
  s_waitcnt lgkmcnt(0)
  s_barrier
  v_mfma_f32_32x32x16_bf16 v[212:227], v[228:231], v[52:55], v[212:227]
  s_cmp_lg_u32 s60, 4
  s_cbranch_scc1 ALskip_80
  v_add_u32 v5, 36864, v1
  ds_read_b128 v[164:167], v5 offset:0
  ds_read_b128 v[168:171], v5 offset:1024
  ds_read_b128 v[172:175], v5 offset:2048
  ds_read_b128 v[176:179], v5 offset:3072
  s_waitcnt lgkmcnt(2)
  v_pk_add_f32 v[164:165], v[164:165], v[168:169]
  v_pk_add_f32 v[166:167], v[166:167], v[170:171]
  s_waitcnt lgkmcnt(1)
  v_pk_add_f32 v[164:165], v[164:165], v[172:173]
  v_pk_add_f32 v[166:167], v[166:167], v[174:175]
  s_waitcnt lgkmcnt(0)
  v_pk_add_f32 v[164:165], v[164:165], v[176:177]
  v_pk_add_f32 v[166:167], v[166:167], v[178:179]
  ds_read_b128 v[168:171], v5 offset:4096
  ds_read_b128 v[172:175], v5 offset:5120
  ds_read_b128 v[176:179], v5 offset:6144
  ds_read_b128 v[2:5], v5 offset:7168
  s_waitcnt lgkmcnt(3)
  v_pk_add_f32 v[164:165], v[164:165], v[168:169]
  v_pk_add_f32 v[166:167], v[166:167], v[170:171]
  s_waitcnt lgkmcnt(2)
  v_pk_add_f32 v[164:165], v[164:165], v[172:173]
  v_pk_add_f32 v[166:167], v[166:167], v[174:175]
  s_waitcnt lgkmcnt(1)
  v_pk_add_f32 v[164:165], v[164:165], v[176:177]
  v_pk_add_f32 v[166:167], v[166:167], v[178:179]
  s_waitcnt lgkmcnt(0)
  v_pk_add_f32 v[164:165], v[164:165], v[2:3]
  v_pk_add_f32 v[166:167], v[166:167], v[4:5]
  v_cvt_pk_bf16_f32 v164, v164, v165
  v_cvt_pk_bf16_f32 v166, v166, v167
  v_mov_b32 v165, s90
  v_mov_b32 v167, s90
  s_lshl_b32 s66, s64, 4
  s_add_u32 s66, s66, s63
  s_lshl_b32 s66, s66, 10
  s_add_u32 s66, s66, 12582912
  buffer_store_dwordx4 v[164:167], v1, s[28:31], s66 offen sc1
ALskip_80:
  ds_read_b64_tr_b16 v[240:241], v25 offset:40960
  v_mov_b32 v252, v28
  s_nop 1
  v_mfma_f32_32x32x16_bf16 v[196:211], v[252:255], v[248:251], v[196:211]
  s_add_u32 s71, s65, 6
  s_and_b32 s71, s71, 7
  s_mul_i32 s85, s71, 176128
  s_add_u32 m0, s77, 0
  s_nop 0
  buffer_load_dwordx4 v13, s[44:47], s85 offen lds
  s_add_u32 s71, s65, 7
  s_and_b32 s71, s71, 7
  s_mul_i32 s85, s71, 176128
  s_add_u32 m0, s77, 8192
  s_nop 0
  buffer_load_dwordx4 v13, s[44:47], s85 offen lds
  v_cvt_pk_bf16_f32 v196, v196, v197
  ds_read_b64_tr_b16 v[242:243], v25 offset:41216
  v_cvt_pk_bf16_f32 v197, v198, v199
  v_cvt_pk_bf16_f32 v198, v200, v201
  v_mfma_f32_32x32x16_bf16 v[212:227], v[232:235], v[56:59], v[212:227]
  v_cvt_pk_bf16_f32 v199, v202, v203
  ds_read_b64_tr_b16 v[228:229], v22 offset:49152
  v_cvt_pk_bf16_f32 v200, v204, v205
  v_cvt_pk_bf16_f32 v201, v206, v207
  s_add_u32 s67, s3, 0
  s_and_b32 s67, s67, 7
  s_lshl_b32 s67, s67, 3
  s_add_u32 s67, s67, 16
  s_add_u32 s67, s67, s60
  s_lshl_b32 s72, s67, 14
  s_lshl_b32 s67, s60, 11
  s_add_u32 m0, s67, 65536
  s_nop 0
  buffer_load_dwordx4 v10, s[36:39], s72 offen lds
  buffer_load_dwordx4 v11, s[36:39], s72 offen offset:1024 lds
  v_cvt_pk_bf16_f32 v202, v208, v209
  ds_read_b64_tr_b16 v[230:231], v22 offset:49408
  v_cvt_pk_bf16_f32 v203, v210, v211
  v_mfma_f32_32x32x16_bf16 v[180:195], v[244:247], v[196:199], 0
  v_mfma_f32_32x32x16_bf16 v[212:227], v[236:239], v[60:63], v[212:227]
  v_mfma_f32_32x32x16_bf16 v[180:195], v[30:33], v[200:203], v[180:195]
  ds_read_b64_tr_b16 v[232:233], v23 offset:49152
  s_nop 10
  v_max3_f32 v2, v180, v181, v182
  v_max3_f32 v12, v188, v189, v190
  v_max3_f32 v3, -v180, -v181, -v182
  ds_read_b64_tr_b16 v[234:235], v23 offset:49408
  v_max3_f32 v13, -v188, -v189, -v190
  v_max3_f32 v4, v183, v184, v185
  s_waitcnt lgkmcnt(4)
  v_mfma_f32_32x32x16_bf16 v[212:227], v[240:243], v[64:67], v[212:227]
  v_max3_f32 v14, v191, v192, v193
  ds_read_b64_tr_b16 v[236:237], v24 offset:49152
  v_max3_f32 v6, -v183, -v184, -v185
  v_max3_f32 v16, -v191, -v192, -v193
  s_add_u32 s67, s3, 1
  s_and_b32 s67, s67, 7
  s_lshl_b32 s67, s67, 3
  s_add_u32 s67, s67, 16
  s_add_u32 s67, s67, s60
  s_lshl_b32 s72, s67, 14
  s_lshl_b32 s67, s60, 11
  s_add_u32 m0, s67, 81920
  s_nop 0
  buffer_load_dwordx4 v10, s[36:39], s72 offen lds
  buffer_load_dwordx4 v11, s[36:39], s72 offen offset:1024 lds
  v_max3_f32 v2, v2, v186, v187
  ds_read_b64_tr_b16 v[238:239], v24 offset:49408
  v_max3_f32 v12, v12, v194, v195
  v_max3_f32 v3, v3, -v186, -v187
  s_waitcnt lgkmcnt(4)
  v_mfma_f32_32x32x16_bf16 v[212:227], v[228:231], v[68:71], v[212:227]
  v_max3_f32 v13, v13, -v194, -v195
  ds_read_b64_tr_b16 v[240:241], v25 offset:49152
  v_max_f32 v2, v2, v4
  v_max_f32 v12, v12, v14
  v_max_f32 v3, v3, v6
  ds_read_b64_tr_b16 v[242:243], v25 offset:49408
  v_max_f32 v13, v13, v16
  v_permlane32_swap_b32 v2, v3
  s_waitcnt lgkmcnt(4)
  v_mfma_f32_32x32x16_bf16 v[212:227], v[232:235], v[72:75], v[212:227]
  v_permlane32_swap_b32 v12, v13
  ds_read_b64_tr_b16 v[228:229], v22 offset:57344
  v_max_f32 v4, v2, v3
  v_max_f32 v14, v12, v13
  s_add_u32 s67, s3, 5
  s_and_b32 s67, s67, 7
  s_lshl_b32 s67, s67, 3
  s_add_u32 s67, s67, 16
  s_add_u32 s67, s67, s60
  s_lshl_b32 s72, s67, 14
  s_lshl_b32 s67, s60, 11
  s_add_u32 m0, s67, 147456
  s_nop 0
  buffer_load_dwordx4 v10, s[36:39], s72 offen lds
  buffer_load_dwordx4 v11, s[36:39], s72 offen offset:1024 lds
  v_mul_f32 v4, v26, v4
  ds_read_b64_tr_b16 v[230:231], v22 offset:57600
  v_mul_f32 v14, v26, v14
  v_mov_b32 v6, v4
  s_waitcnt lgkmcnt(4)
  v_mfma_f32_32x32x16_bf16 v[212:227], v[236:239], v[76:79], v[212:227]
  v_mov_b32 v16, v14
  ds_read_b64_tr_b16 v[232:233], v23 offset:57344
  v_permlane32_swap_b32 v4, v6
  v_permlane32_swap_b32 v14, v16
  v_pk_fma_f32 v[204:205], v[180:181], v[26:27], v[6:7] op_sel_hi:[1,0,0] neg_lo:[1,0,1] neg_hi:[1,0,1]
  ds_read_b64_tr_b16 v[234:235], v23 offset:57600
  v_pk_fma_f32 v[196:197], v[188:189], v[26:27], v[16:17] op_sel_hi:[1,0,0] neg_lo:[1,0,1] neg_hi:[1,0,1]
  v_pk_fma_f32 v[180:181], v[180:181], v[26:27], v[4:5] op_sel_hi:[1,0,0] neg_lo:[0,0,1] neg_hi:[0,0,1]
  s_waitcnt lgkmcnt(4)
  v_mfma_f32_32x32x16_bf16 v[212:227], v[240:243], v[80:83], v[212:227]
  v_pk_fma_f32 v[188:189], v[188:189], v[26:27], v[14:15] op_sel_hi:[1,0,0] neg_lo:[0,0,1] neg_hi:[0,0,1]
  ds_read_b64_tr_b16 v[236:237], v24 offset:57344
  v_pk_fma_f32 v[206:207], v[182:183], v[26:27], v[6:7] op_sel_hi:[1,0,0] neg_lo:[1,0,1] neg_hi:[1,0,1]
  v_pk_fma_f32 v[198:199], v[190:191], v[26:27], v[16:17] op_sel_hi:[1,0,0] neg_lo:[1,0,1] neg_hi:[1,0,1]
  v_pk_fma_f32 v[182:183], v[182:183], v[26:27], v[4:5] op_sel_hi:[1,0,0] neg_lo:[0,0,1] neg_hi:[0,0,1]
  ds_read_b64_tr_b16 v[238:239], v24 offset:57600
  v_pk_fma_f32 v[190:191], v[190:191], v[26:27], v[14:15] op_sel_hi:[1,0,0] neg_lo:[0,0,1] neg_hi:[0,0,1]
  v_pk_fma_f32 v[208:209], v[184:185], v[26:27], v[6:7] op_sel_hi:[1,0,0] neg_lo:[1,0,1] neg_hi:[1,0,1]
  s_waitcnt lgkmcnt(4)
  v_mfma_f32_32x32x16_bf16 v[212:227], v[228:231], v[84:87], v[212:227]
  v_pk_fma_f32 v[200:201], v[192:193], v[26:27], v[16:17] op_sel_hi:[1,0,0] neg_lo:[1,0,1] neg_hi:[1,0,1]
  ds_read_b64_tr_b16 v[240:241], v25 offset:57344
  v_pk_fma_f32 v[184:185], v[184:185], v[26:27], v[4:5] op_sel_hi:[1,0,0] neg_lo:[0,0,1] neg_hi:[0,0,1]
  v_pk_fma_f32 v[192:193], v[192:193], v[26:27], v[14:15] op_sel_hi:[1,0,0] neg_lo:[0,0,1] neg_hi:[0,0,1]
  v_pk_fma_f32 v[210:211], v[186:187], v[26:27], v[6:7] op_sel_hi:[1,0,0] neg_lo:[1,0,1] neg_hi:[1,0,1]
  ds_read_b64_tr_b16 v[242:243], v25 offset:57600
  v_pk_fma_f32 v[202:203], v[194:195], v[26:27], v[16:17] op_sel_hi:[1,0,0] neg_lo:[1,0,1] neg_hi:[1,0,1]
  v_pk_fma_f32 v[186:187], v[186:187], v[26:27], v[4:5] op_sel_hi:[1,0,0] neg_lo:[0,0,1] neg_hi:[0,0,1]
  s_waitcnt vmcnt(6)
  s_barrier
  s_waitcnt lgkmcnt(4)
  v_mfma_f32_32x32x16_bf16 v[212:227], v[232:235], v[88:91], v[212:227]
  v_pk_fma_f32 v[194:195], v[194:195], v[26:27], v[14:15] op_sel_hi:[1,0,0] neg_lo:[0,0,1] neg_hi:[0,0,1]
  v_add_u32 v22, 4294901760, v22
  v_add_u32 v23, 4294901760, v23
  v_add_u32 v24, 4294901760, v24
  v_add_u32 v25, 4294901760, v25
  ds_read_b64_tr_b16 v[228:229], v22 offset:49152
  v_exp_f32 v204, v204
  v_exp_f32 v196, v196
  v_exp_f32 v180, v180
  ds_read_b64_tr_b16 v[230:231], v22 offset:49408
  v_exp_f32 v188, v188
  v_exp_f32 v205, v205
  s_waitcnt lgkmcnt(4)
  v_mfma_f32_32x32x16_bf16 v[212:227], v[236:239], v[92:95], v[212:227]
  v_exp_f32 v197, v197
  ds_read_b64_tr_b16 v[232:233], v23 offset:49152
  v_exp_f32 v181, v181
  v_exp_f32 v189, v189
  s_add_u32 s67, s3, 2
  s_and_b32 s67, s67, 7
  s_lshl_b32 s67, s67, 3
  s_add_u32 s67, s67, 16
  s_add_u32 s67, s67, s60
  s_lshl_b32 s72, s67, 14
  s_lshl_b32 s67, s60, 11
  s_add_u32 m0, s67, 98304
  s_nop 0
  buffer_load_dwordx4 v10, s[36:39], s72 offen lds
  buffer_load_dwordx4 v11, s[36:39], s72 offen offset:1024 lds
  v_exp_f32 v206, v206
  ds_read_b64_tr_b16 v[234:235], v23 offset:49408
  v_exp_f32 v198, v198
  v_exp_f32 v182, v182
  s_waitcnt lgkmcnt(4)
  v_mfma_f32_32x32x16_bf16 v[212:227], v[240:243], v[96:99], v[212:227]
  v_exp_f32 v190, v190
  ds_read_b64_tr_b16 v[236:237], v24 offset:49152
  v_exp_f32 v207, v207
  v_exp_f32 v199, v199
  v_exp_f32 v183, v183
  ds_read_b64_tr_b16 v[238:239], v24 offset:49408
  v_exp_f32 v191, v191
  v_exp_f32 v208, v208
  s_waitcnt lgkmcnt(4)
  v_mfma_f32_32x32x16_bf16 v[212:227], v[228:231], v[100:103], v[212:227]
  v_exp_f32 v200, v200
  ds_read_b64_tr_b16 v[240:241], v25 offset:49152
  v_exp_f32 v184, v184
  v_exp_f32 v192, v192
  s_add_u32 s67, s3, 4
  s_and_b32 s67, s67, 7
  s_lshl_b32 s67, s67, 3
  s_add_u32 s67, s67, 16
  s_add_u32 s67, s67, s60
  s_lshl_b32 s72, s67, 14
  s_lshl_b32 s67, s60, 11
  s_add_u32 m0, s67, 131072
  s_nop 0
  buffer_load_dwordx4 v10, s[36:39], s72 offen lds
  buffer_load_dwordx4 v11, s[36:39], s72 offen offset:1024 lds
  v_exp_f32 v209, v209
  ds_read_b64_tr_b16 v[242:243], v25 offset:49408
  v_exp_f32 v201, v201
  v_exp_f32 v185, v185
  s_waitcnt lgkmcnt(4)
  v_mfma_f32_32x32x16_bf16 v[212:227], v[232:235], v[104:107], v[212:227]
  v_exp_f32 v193, v193
  ds_read_b64_tr_b16 v[228:229], v22 offset:57344
  v_exp_f32 v210, v210
  v_exp_f32 v202, v202
  v_exp_f32 v186, v186
  ds_read_b64_tr_b16 v[230:231], v22 offset:57600
  v_exp_f32 v194, v194
  v_exp_f32 v211, v211
  s_waitcnt lgkmcnt(4)
  v_mfma_f32_32x32x16_bf16 v[212:227], v[236:239], v[108:111], v[212:227]
  v_exp_f32 v203, v203
  ds_read_b64_tr_b16 v[232:233], v23 offset:57344
  v_exp_f32 v187, v187
  v_exp_f32 v195, v195
  v_pk_add_f32 v[4:5], v[180:181], v[182:183]
  ds_read_b64_tr_b16 v[234:235], v23 offset:57600
  v_pk_add_f32 v[14:15], v[188:189], v[190:191]
  v_pk_add_f32 v[6:7], v[204:205], v[206:207]
  s_waitcnt lgkmcnt(4)
  v_mfma_f32_32x32x16_bf16 v[212:227], v[240:243], v[112:115], v[212:227]
  v_pk_add_f32 v[16:17], v[196:197], v[198:199]
  ds_read_b64_tr_b16 v[236:237], v24 offset:57344
  v_pk_add_f32 v[2:3], v[184:185], v[186:187]
  v_pk_add_f32 v[12:13], v[192:193], v[194:195]
  v_pk_add_f32 v[6:7], v[6:7], v[208:209]
  ds_read_b64_tr_b16 v[238:239], v24 offset:57600
  v_pk_add_f32 v[16:17], v[16:17], v[200:201]
  v_pk_add_f32 v[4:5], v[4:5], v[2:3]
  s_waitcnt lgkmcnt(4)
  v_mfma_f32_32x32x16_bf16 v[212:227], v[228:231], v[116:119], v[212:227]
  v_pk_add_f32 v[14:15], v[14:15], v[12:13]
  ds_read_b64_tr_b16 v[240:241], v25 offset:57344
  v_pk_add_f32 v[6:7], v[6:7], v[210:211]
  v_pk_add_f32 v[16:17], v[16:17], v[202:203]
  s_lshl_b32 s84, s64, 3
  s_add_u32 s84, s84, s60
  s_lshl_b32 s84, s84, 11
  s_add_u32 s84, s84, 12582912
  s_add_u32 s66, s84, 0
  buffer_load_dwordx4 v[164:167], v1, s[28:31], s66 offen offset:0 sc1
  buffer_load_dwordx4 v[168:171], v1, s[28:31], s66 offen offset:1024 sc1
  v_add_f32 v2, v4, v5
  ds_read_b64_tr_b16 v[242:243], v25 offset:57600
  v_add_f32 v12, v14, v15
  v_add_f32 v3, v6, v7
  s_waitcnt lgkmcnt(4)
  v_mfma_f32_32x32x16_bf16 v[212:227], v[232:235], v[120:123], v[212:227]
  v_add_f32 v13, v16, v17
  ds_read_b64_tr_b16 v[228:229], v22 offset:0
  v_permlane32_swap_b32 v2, v3
  v_permlane32_swap_b32 v12, v13
  v_add_f32 v4, v2, v3
  ds_read_b64_tr_b16 v[230:231], v22 offset:256
  v_add_f32 v14, v12, v13
  v_rcp_f32 v4, v4
  s_waitcnt lgkmcnt(4)
  v_mfma_f32_32x32x16_bf16 v[212:227], v[236:239], v[124:127], v[212:227]
  v_rcp_f32 v14, v14
  ds_read_b64_tr_b16 v[232:233], v23 offset:0
  v_mov_b32 v6, v4
  v_mov_b32 v16, v14
  s_nop 0
  v_permlane32_swap_b32 v4, v6
  ds_read_b64_tr_b16 v[234:235], v23 offset:256
  v_permlane32_swap_b32 v14, v16
  v_pk_mul_f32 v[180:181], v[180:181], v[4:5] op_sel_hi:[1,0]
  s_waitcnt lgkmcnt(4)
  v_mfma_f32_32x32x16_bf16 v[212:227], v[240:243], v[128:131], v[212:227]
  v_pk_mul_f32 v[188:189], v[188:189], v[14:15] op_sel_hi:[1,0]
  ds_read_b64_tr_b16 v[236:237], v24 offset:0
  v_pk_mul_f32 v[204:205], v[204:205], v[6:7] op_sel_hi:[1,0]
  v_pk_mul_f32 v[196:197], v[196:197], v[16:17] op_sel_hi:[1,0]
  v_pk_mul_f32 v[182:183], v[182:183], v[4:5] op_sel_hi:[1,0]
  ds_read_b64_tr_b16 v[238:239], v24 offset:256
  v_pk_mul_f32 v[190:191], v[190:191], v[14:15] op_sel_hi:[1,0]
  v_pk_mul_f32 v[206:207], v[206:207], v[6:7] op_sel_hi:[1,0]
  s_waitcnt lgkmcnt(4)
  v_mfma_f32_32x32x16_bf16 v[212:227], v[228:231], v[132:135], v[212:227]
  v_pk_mul_f32 v[198:199], v[198:199], v[16:17] op_sel_hi:[1,0]
  ds_read_b64_tr_b16 v[240:241], v25 offset:0
  v_pk_mul_f32 v[184:185], v[184:185], v[4:5] op_sel_hi:[1,0]
  v_pk_mul_f32 v[192:193], v[192:193], v[14:15] op_sel_hi:[1,0]
  v_pk_mul_f32 v[208:209], v[208:209], v[6:7] op_sel_hi:[1,0]
  ds_read_b64_tr_b16 v[242:243], v25 offset:256
  v_pk_mul_f32 v[200:201], v[200:201], v[16:17] op_sel_hi:[1,0]
  v_pk_mul_f32 v[186:187], v[186:187], v[4:5] op_sel_hi:[1,0]
  s_waitcnt lgkmcnt(4)
  v_mfma_f32_32x32x16_bf16 v[212:227], v[232:235], v[136:139], v[212:227]
  v_pk_mul_f32 v[194:195], v[194:195], v[14:15] op_sel_hi:[1,0]
  ds_read_b64_tr_b16 v[228:229], v22 offset:8192
  v_pk_mul_f32 v[210:211], v[210:211], v[6:7] op_sel_hi:[1,0]
  v_pk_mul_f32 v[202:203], v[202:203], v[16:17] op_sel_hi:[1,0]
  v_cvt_pk_bf16_f32 v180, v180, v181
  ds_read_b64_tr_b16 v[230:231], v22 offset:8448
  v_cvt_pk_bf16_f32 v188, v188, v189
  v_cvt_pk_bf16_f32 v204, v204, v205
  s_waitcnt lgkmcnt(4)
  v_mfma_f32_32x32x16_bf16 v[212:227], v[236:239], v[140:143], v[212:227]
  v_cvt_pk_bf16_f32 v196, v196, v197
  ds_read_b64_tr_b16 v[232:233], v23 offset:8192
  v_cvt_pk_bf16_f32 v181, v182, v183
  v_cvt_pk_bf16_f32 v189, v190, v191
  v_cvt_pk_bf16_f32 v205, v206, v207
  ds_read_b64_tr_b16 v[234:235], v23 offset:8448
  v_cvt_pk_bf16_f32 v197, v198, v199
  v_cvt_pk_bf16_f32 v182, v184, v185
  s_waitcnt lgkmcnt(4)
  v_mfma_f32_32x32x16_bf16 v[212:227], v[240:243], v[144:147], v[212:227]
  v_cvt_pk_bf16_f32 v190, v192, v193
  ds_read_b64_tr_b16 v[236:237], v24 offset:8192
  v_cvt_pk_bf16_f32 v206, v208, v209
  v_cvt_pk_bf16_f32 v198, v200, v201
  v_cvt_pk_bf16_f32 v183, v186, v187
  ds_read_b64_tr_b16 v[238:239], v24 offset:8448
  v_cvt_pk_bf16_f32 v191, v194, v195
  v_cvt_pk_bf16_f32 v207, v210, v211
  s_waitcnt lgkmcnt(4)
  v_mfma_f32_32x32x16_bf16 v[212:227], v[228:231], v[148:151], v[212:227]
  ds_read_b64_tr_b16 v[240:241], v25 offset:8192
  v_cvt_pk_bf16_f32 v199, v202, v203
  ds_read_b64_tr_b16 v[242:243], v25 offset:8448
  s_waitcnt lgkmcnt(4)
  v_mfma_f32_32x32x16_bf16 v[212:227], v[232:235], v[152:155], v[212:227]
  s_waitcnt lgkmcnt(2)
  v_mfma_f32_32x32x16_bf16 v[212:227], v[236:239], v[156:159], v[212:227]
  s_waitcnt lgkmcnt(0)
  v_mfma_f32_32x32x16_bf16 v[212:227], v[240:243], v[160:163], v[212:227]
  s_lshl_b32 s79, s63, 2
  s_add_u32 s79, s79, s61
  s_mul_i32 s79, s79, 118
  s_lshl_b32 s66, s64, 1
  s_add_u32 s66, s66, s62
  s_add_u32 s81, s79, s66
  s_add_u32 s81, s81, s66
  s_add_u32 s81, s81, 86
  s_lshl_b32 s81, s81, 10
  s_add_u32 s79, s79, s66
  s_lshl_b32 s79, s79, 10
  s_lshl_b32 s84, s64, 3
  s_add_u32 s84, s84, s60
  s_lshl_b32 s84, s84, 11
  s_add_u32 s84, s84, 12582912
  v_mov_b32 v252, v29
  s_nop 1
  v_mfma_f32_32x32x16_bf16 v[212:227], v[252:255], v[248:251], v[212:227]
  v_and_b32 v14, 7, v0
  v_lshlrev_b32 v14, 7, v14
  s_lshr_b32 s78, s27, 1
  s_lshl_b32 s78, s78, 10
  s_add_u32 s78, s78, 15220736
  s_mov_b32 s80, 0
  buffer_load_dwordx2 v[12:13], v14, s[28:31], s78 offen sc1
  s_waitcnt vmcnt(2)
  v_min_u32 v2, v165, v167
  s_waitcnt vmcnt(1)
  v_min3_u32 v2, v2, v169, v171
  v_max_u32 v3, v165, v167
  v_max3_u32 v3, v3, v169, v171
  v_cmp_eq_u32 vcc, s90, v2
  v_cmp_eq_u32 s[96:97], s90, v3
  s_nop 0
  s_and_b64 vcc, vcc, s[96:97]
  s_cmp_eq_u64 vcc, -1
  s_cbranch_scc0 ALrare_81
ALback_82:
  v_mov_b32 v165, v166
  v_mov_b32 v166, v168
  v_mov_b32 v167, v170
  s_lshl_b32 s66, s60, 10
  s_add_u32 s66, s66, 36864
  v_add_u32 v5, s66, v1
  s_lshl_b32 s66, s62, 12
  s_add_u32 s66, s66, 36864
  v_add_u32 v6, s66, v1
  ds_write_b128 v5, v[164:167]
  s_waitcnt lgkmcnt(0)
  s_barrier
  s_add_u32 s67, s3, 3
  s_and_b32 s67, s67, 7
  s_lshl_b32 s67, s67, 3
  s_add_u32 s67, s67, 16
  s_add_u32 s67, s67, s60
  s_lshl_b32 s72, s67, 14
  s_lshl_b32 s67, s60, 11
  s_add_u32 m0, s67, 114688
  s_nop 0
  buffer_load_dwordx4 v10, s[36:39], s72 offen lds
  buffer_load_dwordx4 v11, s[36:39], s72 offen offset:1024 lds
  ds_read_b128 v[36:39], v6 offset:0
  ds_read_b128 v[40:43], v6 offset:1024
  ds_read_b128 v[44:47], v6 offset:2048
  ds_read_b128 v[48:51], v6 offset:3072
  s_waitcnt lgkmcnt(3)
  v_mfma_f32_32x32x16_bf16 v[52:67], v[36:39], v[180:183], 0
  s_waitcnt lgkmcnt(2)
  v_mfma_f32_32x32x16_bf16 v[52:67], v[40:43], v[204:207], v[52:67]
  s_waitcnt lgkmcnt(1)
  v_mfma_f32_32x32x16_bf16 v[68:83], v[44:47], v[188:191], 0
  s_waitcnt lgkmcnt(0)
  v_mfma_f32_32x32x16_bf16 v[68:83], v[48:51], v[196:199], v[68:83]
  v_mul_f32 v4, v35, v35
  v_mul_f32 v2, 3216550459, v34
  v_pk_mul_f32 v[236:237], v[212:213], v[2:3] op_sel_hi:[1,0]
  v_pk_mul_f32 v[238:239], v[214:215], v[2:3] op_sel_hi:[1,0]
  v_pk_mul_f32 v[240:241], v[216:217], v[2:3] op_sel_hi:[1,0]
  v_pk_mul_f32 v[242:243], v[218:219], v[2:3] op_sel_hi:[1,0]
  v_exp_f32 v236, v236
  v_exp_f32 v237, v237
  v_exp_f32 v238, v238
  v_exp_f32 v239, v239
  v_exp_f32 v240, v240
  v_exp_f32 v241, v241
  v_exp_f32 v242, v242
  v_exp_f32 v243, v243
  v_pk_mul_f32 v[212:213], v[212:213], v[220:221]
  v_pk_mul_f32 v[214:215], v[214:215], v[222:223]
  v_pk_mul_f32 v[216:217], v[216:217], v[224:225]
  v_pk_mul_f32 v[218:219], v[218:219], v[226:227]
  v_pk_fma_f32 v[236:237], v[236:237], v[4:5], v[4:5] op_sel_hi:[1,0,0]
  v_pk_fma_f32 v[238:239], v[238:239], v[4:5], v[4:5] op_sel_hi:[1,0,0]
  v_pk_fma_f32 v[240:241], v[240:241], v[4:5], v[4:5] op_sel_hi:[1,0,0]
  v_pk_fma_f32 v[242:243], v[242:243], v[4:5], v[4:5] op_sel_hi:[1,0,0]
  v_rcp_f32 v236, v236
  v_rcp_f32 v237, v237
  v_rcp_f32 v238, v238
  v_rcp_f32 v239, v239
  v_rcp_f32 v240, v240
  v_rcp_f32 v241, v241
  v_rcp_f32 v242, v242
  v_rcp_f32 v243, v243
  v_pk_mul_f32 v[212:213], v[212:213], v[236:237]
  v_pk_mul_f32 v[214:215], v[214:215], v[238:239]
  v_pk_mul_f32 v[216:217], v[216:217], v[240:241]
  v_pk_mul_f32 v[218:219], v[218:219], v[242:243]
  v_cvt_pk_bf16_f32 v212, v212, v213
  v_cvt_pk_bf16_f32 v213, v214, v215
  v_cvt_pk_bf16_f32 v214, v216, v217
  v_cvt_pk_bf16_f32 v215, v218, v219
  buffer_store_dwordx4 v[212:215], v1, s[28:31], s79 offen sc1
  v_add_f32 v2, 0x358637bd, v60
  v_rcp_f32 v2, v2
  s_nop 0
  v_pk_mul_f32 v[52:53], v[52:53], v[2:3] op_sel_hi:[1,0]
  v_pk_mul_f32 v[54:55], v[54:55], v[2:3] op_sel_hi:[1,0]
  v_pk_mul_f32 v[56:57], v[56:57], v[2:3] op_sel_hi:[1,0]
  v_pk_mul_f32 v[58:59], v[58:59], v[2:3] op_sel_hi:[1,0]
  v_cvt_pk_bf16_f32 v52, v52, v53
  v_cvt_pk_bf16_f32 v53, v54, v55
  v_cvt_pk_bf16_f32 v54, v56, v57
  v_cvt_pk_bf16_f32 v55, v58, v59
  buffer_store_dwordx4 v[52:55], v1, s[28:31], s81 offen offset:0 sc1
  v_add_f32 v2, 0x358637bd, v76
  v_rcp_f32 v2, v2
  s_nop 0
  v_pk_mul_f32 v[68:69], v[68:69], v[2:3] op_sel_hi:[1,0]
  v_pk_mul_f32 v[70:71], v[70:71], v[2:3] op_sel_hi:[1,0]
  v_pk_mul_f32 v[72:73], v[72:73], v[2:3] op_sel_hi:[1,0]
  v_pk_mul_f32 v[74:75], v[74:75], v[2:3] op_sel_hi:[1,0]
  v_cvt_pk_bf16_f32 v68, v68, v69
  v_cvt_pk_bf16_f32 v69, v70, v71
  v_cvt_pk_bf16_f32 v70, v72, v73
  v_cvt_pk_bf16_f32 v71, v74, v75
  buffer_store_dwordx4 v[68:71], v1, s[28:31], s81 offen offset:1024 sc1
  s_waitcnt vmcnt(0)
  s_barrier
  s_cmp_lg_u32 s60, 0
  s_cbranch_scc1 ALskip_85
  s_lshl_b32 s67, s63, 3
  s_add_u32 s67, s67, s64
  s_lshl_b32 s67, s67, 7
  s_add_u32 s67, s67, 15204352
  v_mov_b32 v4, s90
  v_mov_b32 v5, s91
  v_mov_b32 v6, 0
  s_mov_b64 exec, 1
  buffer_store_dwordx2 v[4:5], v6, s[28:31], s67 offen sc1
  s_mov_b64 exec, -1
ALskip_85:
parallel_sum__linear_kernel_hedgehog__glu_gated_swiglu__prompt_kernel_ph2:
  s_setprio 0
  s_cmp_lt_u32 s60, 4
  s_cbranch_scc0 ALelse_86
  s_mov_b32 s44, s20
  s_mov_b32 s45, s21
  s_mov_b32 s46, 2097152
  s_mov_b32 s47, 0x20000
  s_lshl_b32 s66, s27, 1
  s_and_b32 s67, s60, 1
  s_add_u32 s66, s66, s67
  s_lshl_b32 s66, s66, 15
  s_lshl_b32 s68, s26, 7
  s_add_u32 s66, s66, s68
  s_lshr_b32 s68, s60, 1
  s_lshl_b32 s69, s68, 6
  s_add_u32 s66, s66, s69
  v_and_b32 v2, 31, v0
  v_lshlrev_b32 v2, 10, v2
  v_add_u32 v2, s66, v2
  v_lshrrev_b32 v3, 5, v0
  v_lshl_add_u32 v20, v3, 4, v2
  v_and_b32 v2, 31, v0
  v_lshlrev_b32 v21, 7, v2
  v_lshl_add_u32 v21, v3, 3, v21
  v_bfe_u32 v2, v0, 1, 1
  v_lshlrev_b32 v2, 6, v2
  v_xor_b32 v2, s69, v2
  v_add_u32 v21, v21, v2
  s_lshl_b32 s66, s67, 12
  s_add_u32 s66, s66, 114688
  v_add_u32 v21, s66, v21
  s_lshl_b32 s67, s67, 13
  v_add_u32 v16, s67, v1
  v_lshrrev_b32 v2, 5, v0
  v_bfe_u32 v3, v0, 2, 2
  v_lshl_add_u32 v2, v2, 2, v3
  v_lshlrev_b32 v17, 7, v2
  v_bfe_u32 v2, v0, 4, 1
  v_bfe_u32 v3, v0, 1, 1
  v_lshl_add_u32 v2, v2, 1, v3
  s_lshl_b32 s68, s68, 2
  v_add_u32 v2, s68, v2
  v_bfe_u32 v3, v0, 3, 1
  v_lshlrev_b32 v3, 2, v3
  v_xor_b32 v2, v2, v3
  v_lshl_add_u32 v17, v2, 4, v17
  v_and_b32 v2, 1, v0
  v_lshl_add_u32 v17, v2, 3, v17
  v_add_u32 v17, 65536, v17
  s_mov_b32 s74, 0
  s_mov_b32 s76, 0
  s_mov_b32 s75, 0
  v_mov_b64 v[24:25], 0
  v_mov_b64 v[26:27], 0
  v_mov_b64 v[28:29], 0
  v_mov_b64 v[30:31], 0
  v_mov_b64 v[32:33], 0
  v_mov_b64 v[34:35], 0
  v_mov_b64 v[36:37], 0
  v_mov_b64 v[38:39], 0
  v_mov_b64 v[56:57], 0
  v_mov_b64 v[88:89], 0
  v_mov_b64 v[58:59], 0
  v_mov_b64 v[90:91], 0
  v_mov_b64 v[60:61], 0
  v_mov_b64 v[92:93], 0
  v_mov_b64 v[62:63], 0
  v_mov_b64 v[94:95], 0
  v_mov_b64 v[64:65], 0
  v_mov_b64 v[96:97], 0
  v_mov_b64 v[66:67], 0
  v_mov_b64 v[98:99], 0
  v_mov_b64 v[68:69], 0
  v_mov_b64 v[100:101], 0
  v_mov_b64 v[70:71], 0
  v_mov_b64 v[102:103], 0
  s_waitcnt vmcnt(0)
  v_add_u32 v18, s74, v16
  v_add_u32 v19, s76, v17
parallel_sum__linear_kernel_hedgehog__glu_gated_swiglu__prompt_kernel_cl:
  s_waitcnt lgkmcnt(0)
  s_barrier
  v_mfma_f32_32x32x16_bf16 v[24:39], v[88:91], v[56:59], v[24:39]
  ds_read_b128 v[40:43], v18 offset:0
  ds_read_b64_tr_b16 v[72:73], v19 offset:0
  ds_read_b64_tr_b16 v[74:75], v19 offset:1024
  v_mfma_f32_32x32x16_bf16 v[24:39], v[92:95], v[60:63], v[24:39]
  ds_read_b128 v[44:47], v18 offset:1024
  ds_read_b64_tr_b16 v[76:77], v19 offset:2048
  ds_read_b64_tr_b16 v[78:79], v19 offset:3072
  s_cmp_eq_u32 s75, 9
  s_cbranch_scc1 ALrare_88
  v_mfma_f32_32x32x16_bf16 v[24:39], v[96:99], v[64:67], v[24:39]
  ds_read_b128 v[48:51], v18 offset:2048
  ds_read_b64_tr_b16 v[80:81], v19 offset:4096
  ds_read_b64_tr_b16 v[82:83], v19 offset:5120
  v_mfma_f32_32x32x16_bf16 v[24:39], v[100:103], v[68:71], v[24:39]
  ds_read_b128 v[52:55], v18 offset:3072
  ds_read_b64_tr_b16 v[84:85], v19 offset:6144
  ds_read_b64_tr_b16 v[86:87], v19 offset:7168
ALback_89:
  s_waitcnt lgkmcnt(9)
  v_mfma_f32_32x32x16_bf16 v[24:39], v[72:75], v[40:43], v[24:39]
  ds_read_b128 v[56:59], v18 offset:4096
  ds_read_b64_tr_b16 v[88:89], v19 offset:8192
  ds_read_b64_tr_b16 v[90:91], v19 offset:9216
  ds_read_b128 v[60:63], v18 offset:5120
  ds_read_b64_tr_b16 v[92:93], v19 offset:10240
  ds_read_b64_tr_b16 v[94:95], v19 offset:11264
  s_waitcnt lgkmcnt(12)
  v_mfma_f32_32x32x16_bf16 v[24:39], v[76:79], v[44:47], v[24:39]
  ds_read_b128 v[64:67], v18 offset:6144
  ds_read_b64_tr_b16 v[96:97], v19 offset:12288
  ds_read_b64_tr_b16 v[98:99], v19 offset:13312
  ds_read_b128 v[68:71], v18 offset:7168
  ds_read_b64_tr_b16 v[100:101], v19 offset:14336
  ds_read_b64_tr_b16 v[102:103], v19 offset:15360
  s_waitcnt lgkmcnt(15)
  v_mfma_f32_32x32x16_bf16 v[24:39], v[80:83], v[48:51], v[24:39]
  s_add_u32 s74, s74, 16384
  s_cmp_ge_u32 s74, 65536
  s_cselect_b32 s74, 0, s74
  s_add_u32 s76, s76, 16384
  s_cmp_ge_u32 s76, 98304
  s_cselect_b32 s76, 0, s76
  s_add_u32 s75, s75, 1
  v_add_u32 v18, s74, v16
  v_add_u32 v19, s76, v17
  s_waitcnt lgkmcnt(12)
  v_mfma_f32_32x32x16_bf16 v[24:39], v[84:87], v[52:55], v[24:39]
  s_cmp_lt_u32 s75, 15
  s_cbranch_scc1 parallel_sum__linear_kernel_hedgehog__glu_gated_swiglu__prompt_kernel_cl
  ds_read_b64 v[104:105], v21 offset:0
  ds_read_b64 v[106:107], v21 offset:16
  ds_read_b64 v[108:109], v21 offset:32
  ds_read_b64 v[110:111], v21 offset:48
  s_waitcnt lgkmcnt(13)
  v_mfma_f32_32x32x16_bf16 v[24:39], v[88:91], v[56:59], v[24:39]
  s_waitcnt lgkmcnt(10)
  v_mfma_f32_32x32x16_bf16 v[24:39], v[92:95], v[60:63], v[24:39]
  s_waitcnt lgkmcnt(7)
  v_mfma_f32_32x32x16_bf16 v[24:39], v[96:99], v[64:67], v[24:39]
  s_waitcnt lgkmcnt(4)
  v_mfma_f32_32x32x16_bf16 v[24:39], v[100:103], v[68:71], v[24:39]
  s_waitcnt lgkmcnt(3)
  v_lshlrev_b32 v40, 16, v104
  v_and_b32 v41, 0xffff0000, v104
  v_lshlrev_b32 v42, 16, v105
  v_and_b32 v43, 0xffff0000, v105
  s_waitcnt lgkmcnt(2)
  v_lshlrev_b32 v44, 16, v106
  v_and_b32 v45, 0xffff0000, v106
  v_lshlrev_b32 v46, 16, v107
  v_and_b32 v47, 0xffff0000, v107
  s_waitcnt lgkmcnt(1)
  v_lshlrev_b32 v48, 16, v108
  v_and_b32 v49, 0xffff0000, v108
  v_lshlrev_b32 v50, 16, v109
  v_and_b32 v51, 0xffff0000, v109
  s_waitcnt lgkmcnt(0)
  v_lshlrev_b32 v52, 16, v110
  v_and_b32 v53, 0xffff0000, v110
  v_lshlrev_b32 v54, 16, v111
  v_and_b32 v55, 0xffff0000, v111
  v_pk_add_f32 v[40:41], v[40:41], v[24:25]
  v_pk_add_f32 v[42:43], v[42:43], v[26:27]
  v_pk_add_f32 v[44:45], v[44:45], v[28:29]
  v_pk_add_f32 v[46:47], v[46:47], v[30:31]
  v_pk_add_f32 v[48:49], v[48:49], v[32:33]
  v_pk_add_f32 v[50:51], v[50:51], v[34:35]
  v_pk_add_f32 v[52:53], v[52:53], v[36:37]
  v_pk_add_f32 v[54:55], v[54:55], v[38:39]
  v_cvt_pk_bf16_f32 v72, v40, v41
  v_cvt_pk_bf16_f32 v73, v42, v43
  v_cvt_pk_bf16_f32 v74, v44, v45
  v_cvt_pk_bf16_f32 v75, v46, v47
  v_cvt_pk_bf16_f32 v76, v48, v49
  v_cvt_pk_bf16_f32 v77, v50, v51
  v_cvt_pk_bf16_f32 v78, v52, v53
  v_cvt_pk_bf16_f32 v79, v54, v55
  v_permlane32_swap_b32 v72, v74
  v_permlane32_swap_b32 v73, v75
  buffer_store_dwordx4 v[72:75], v20, s[44:47], 0 offen offset:0
  v_permlane32_swap_b32 v76, v78
  v_permlane32_swap_b32 v77, v79
  buffer_store_dwordx4 v[76:79], v20, s[44:47], 0 offen offset:32
  s_branch ALend_87
ALelse_86:
  s_cmp_lt_u32 s60, 6
  s_cbranch_scc0 ALelse_90
  s_cmp_lg_u32 s80, 0
  s_cbranch_scc1 ALskip_92
  s_lshl_b32 s74, s27, 1
  s_and_b32 s66, s60, 1
  s_add_u32 s74, s74, s66
  s_mul_i32 s74, s74, 120832
  s_lshl_b32 s76, s66, 13
  s_waitcnt vmcnt(0)
  v_cmp_eq_u64 vcc, s[90:91], v[12:13]
  s_nop 0
  s_cmp_eq_u64 vcc, -1
  s_cbranch_scc0 ALrare_93
ALback_94:
  s_add_u32 s77, s3, 0
  s_and_b32 s77, s77, 7
  s_lshl_b32 s77, s77, 3
  s_add_u32 s77, s77, 16
  s_lshl_b32 s71, s77, 10
  s_add_u32 s71, s71, s74
  s_add_u32 m0, s76, 0
  s_nop 0
  buffer_load_dwordx4 v1, s[28:31], s71 offen offset:0 sc1 lds
  buffer_load_dwordx4 v1, s[28:31], s71 offen offset:1024 sc1 lds
  buffer_load_dwordx4 v1, s[28:31], s71 offen offset:2048 sc1 lds
  buffer_load_dwordx4 v1, s[28:31], s71 offen offset:3072 sc1 lds
  s_add_u32 s71, s71, 4096
  s_add_u32 m0, m0, 4096
  s_nop 0
  buffer_load_dwordx4 v1, s[28:31], s71 offen offset:0 sc1 lds
  buffer_load_dwordx4 v1, s[28:31], s71 offen offset:1024 sc1 lds
  buffer_load_dwordx4 v1, s[28:31], s71 offen offset:2048 sc1 lds
  buffer_load_dwordx4 v1, s[28:31], s71 offen offset:3072 sc1 lds
  s_add_u32 s77, s3, 1
  s_and_b32 s77, s77, 7
  s_lshl_b32 s77, s77, 3
  s_add_u32 s77, s77, 16
  s_lshl_b32 s71, s77, 10
  s_add_u32 s71, s71, s74
  s_add_u32 m0, s76, 16384
  s_nop 0
  buffer_load_dwordx4 v1, s[28:31], s71 offen offset:0 sc1 lds
  buffer_load_dwordx4 v1, s[28:31], s71 offen offset:1024 sc1 lds
  buffer_load_dwordx4 v1, s[28:31], s71 offen offset:2048 sc1 lds
  buffer_load_dwordx4 v1, s[28:31], s71 offen offset:3072 sc1 lds
  s_add_u32 s71, s71, 4096
  s_add_u32 m0, m0, 4096
  s_nop 0
  buffer_load_dwordx4 v1, s[28:31], s71 offen offset:0 sc1 lds
  buffer_load_dwordx4 v1, s[28:31], s71 offen offset:1024 sc1 lds
  buffer_load_dwordx4 v1, s[28:31], s71 offen offset:2048 sc1 lds
  buffer_load_dwordx4 v1, s[28:31], s71 offen offset:3072 sc1 lds
ALskip_92:
  s_sub_u32 s78, s78, 16384
  s_add_u32 s77, s3, 2
  s_and_b32 s77, s77, 7
  s_lshl_b32 s77, s77, 3
  s_add_u32 s77, s77, 16
  s_lshl_b32 s71, s77, 10
  s_add_u32 s71, s71, s74
  s_add_u32 m0, s76, 32768
  s_nop 0
  buffer_load_dwordx4 v1, s[28:31], s71 offen offset:0 sc1 lds
  buffer_load_dwordx4 v1, s[28:31], s71 offen offset:1024 sc1 lds
  buffer_load_dwordx4 v1, s[28:31], s71 offen offset:2048 sc1 lds
  buffer_load_dwordx4 v1, s[28:31], s71 offen offset:3072 sc1 lds
  s_add_u32 s71, s71, 4096
  s_add_u32 m0, m0, 4096
  s_nop 0
  buffer_load_dwordx4 v1, s[28:31], s71 offen offset:0 sc1 lds
  buffer_load_dwordx4 v1, s[28:31], s71 offen offset:1024 sc1 lds
  buffer_load_dwordx4 v1, s[28:31], s71 offen offset:2048 sc1 lds
  buffer_load_dwordx4 v1, s[28:31], s71 offen offset:3072 sc1 lds
  s_add_u32 s77, s3, 3
  s_and_b32 s77, s77, 7
  s_lshl_b32 s77, s77, 3
  s_add_u32 s77, s77, 16
  s_lshl_b32 s71, s77, 10
  s_add_u32 s71, s71, s74
  s_add_u32 m0, s76, 49152
  s_nop 0
  buffer_load_dwordx4 v1, s[28:31], s71 offen offset:0 sc1 lds
  buffer_load_dwordx4 v1, s[28:31], s71 offen offset:1024 sc1 lds
  buffer_load_dwordx4 v1, s[28:31], s71 offen offset:2048 sc1 lds
  buffer_load_dwordx4 v1, s[28:31], s71 offen offset:3072 sc1 lds
  s_add_u32 s71, s71, 4096
  s_add_u32 m0, m0, 4096
  s_nop 0
  buffer_load_dwordx4 v1, s[28:31], s71 offen offset:0 sc1 lds
  buffer_load_dwordx4 v1, s[28:31], s71 offen offset:1024 sc1 lds
  buffer_load_dwordx4 v1, s[28:31], s71 offen offset:2048 sc1 lds
  buffer_load_dwordx4 v1, s[28:31], s71 offen offset:3072 sc1 lds
  s_waitcnt vmcnt(24)
  s_barrier
  s_add_u32 s77, s3, 4
  s_and_b32 s77, s77, 7
  s_lshl_b32 s77, s77, 3
  s_add_u32 s77, s77, 16
  s_lshl_b32 s71, s77, 10
  s_add_u32 s71, s71, s74
  s_add_u32 m0, s76, 0
  s_waitcnt vmcnt(16)
  s_barrier
  buffer_load_dwordx4 v1, s[28:31], s71 offen offset:0 sc1 lds
  buffer_load_dwordx4 v1, s[28:31], s71 offen offset:1024 sc1 lds
  buffer_load_dwordx4 v1, s[28:31], s71 offen offset:2048 sc1 lds
  buffer_load_dwordx4 v1, s[28:31], s71 offen offset:3072 sc1 lds
  s_add_u32 s71, s71, 4096
  s_add_u32 m0, m0, 4096
  s_nop 0
  buffer_load_dwordx4 v1, s[28:31], s71 offen offset:0 sc1 lds
  buffer_load_dwordx4 v1, s[28:31], s71 offen offset:1024 sc1 lds
  buffer_load_dwordx4 v1, s[28:31], s71 offen offset:2048 sc1 lds
  buffer_load_dwordx4 v1, s[28:31], s71 offen offset:3072 sc1 lds
  s_add_u32 s77, s3, 5
  s_and_b32 s77, s77, 7
  s_lshl_b32 s77, s77, 3
  s_add_u32 s77, s77, 16
  s_lshl_b32 s71, s77, 10
  s_add_u32 s71, s71, s74
  s_add_u32 m0, s76, 16384
  s_waitcnt vmcnt(16)
  s_barrier
  buffer_load_dwordx4 v1, s[28:31], s71 offen offset:0 sc1 lds
  buffer_load_dwordx4 v1, s[28:31], s71 offen offset:1024 sc1 lds
  buffer_load_dwordx4 v1, s[28:31], s71 offen offset:2048 sc1 lds
  buffer_load_dwordx4 v1, s[28:31], s71 offen offset:3072 sc1 lds
  s_add_u32 s71, s71, 4096
  s_add_u32 m0, m0, 4096
  s_nop 0
  buffer_load_dwordx4 v1, s[28:31], s71 offen offset:0 sc1 lds
  buffer_load_dwordx4 v1, s[28:31], s71 offen offset:1024 sc1 lds
  buffer_load_dwordx4 v1, s[28:31], s71 offen offset:2048 sc1 lds
  buffer_load_dwordx4 v1, s[28:31], s71 offen offset:3072 sc1 lds
  s_add_u32 s77, s3, 6
  s_and_b32 s77, s77, 7
  s_lshl_b32 s77, s77, 3
  s_add_u32 s77, s77, 16
  s_lshl_b32 s71, s77, 10
  s_add_u32 s71, s71, s74
  s_add_u32 m0, s76, 32768
  s_waitcnt vmcnt(16)
  s_barrier
  buffer_load_dwordx4 v1, s[28:31], s71 offen offset:0 sc1 lds
  buffer_load_dwordx4 v1, s[28:31], s71 offen offset:1024 sc1 lds
  buffer_load_dwordx4 v1, s[28:31], s71 offen offset:2048 sc1 lds
  buffer_load_dwordx4 v1, s[28:31], s71 offen offset:3072 sc1 lds
  s_add_u32 s71, s71, 4096
  s_add_u32 m0, m0, 4096
  s_nop 0
  buffer_load_dwordx4 v1, s[28:31], s71 offen offset:0 sc1 lds
  buffer_load_dwordx4 v1, s[28:31], s71 offen offset:1024 sc1 lds
  buffer_load_dwordx4 v1, s[28:31], s71 offen offset:2048 sc1 lds
  buffer_load_dwordx4 v1, s[28:31], s71 offen offset:3072 sc1 lds
  s_add_u32 s77, s3, 7
  s_and_b32 s77, s77, 7
  s_lshl_b32 s77, s77, 3
  s_add_u32 s77, s77, 16
  s_lshl_b32 s71, s77, 10
  s_add_u32 s71, s71, s74
  s_add_u32 m0, s76, 49152
  s_waitcnt vmcnt(16)
  s_barrier
  buffer_load_dwordx4 v1, s[28:31], s71 offen offset:0 sc1 lds
  buffer_load_dwordx4 v1, s[28:31], s71 offen offset:1024 sc1 lds
  buffer_load_dwordx4 v1, s[28:31], s71 offen offset:2048 sc1 lds
  buffer_load_dwordx4 v1, s[28:31], s71 offen offset:3072 sc1 lds
  s_add_u32 s71, s71, 4096
  s_add_u32 m0, m0, 4096
  s_nop 0
  buffer_load_dwordx4 v1, s[28:31], s71 offen offset:0 sc1 lds
  buffer_load_dwordx4 v1, s[28:31], s71 offen offset:1024 sc1 lds
  buffer_load_dwordx4 v1, s[28:31], s71 offen offset:2048 sc1 lds
  buffer_load_dwordx4 v1, s[28:31], s71 offen offset:3072 sc1 lds
  buffer_load_dwordx2 v[12:13], v14, s[28:31], s78 offen sc1
  s_mov_b32 s77, 80
  s_lshl_b32 s71, s77, 10
  s_add_u32 s71, s71, s74
  s_add_u32 m0, s76, 0
  s_waitcnt vmcnt(17)
  s_barrier
  buffer_load_dwordx4 v1, s[28:31], s71 offen offset:0 sc1 lds
  buffer_load_dwordx4 v1, s[28:31], s71 offen offset:1024 sc1 lds
  buffer_load_dwordx4 v1, s[28:31], s71 offen offset:2048 sc1 lds
  buffer_load_dwordx4 v1, s[28:31], s71 offen offset:3072 sc1 lds
  s_add_u32 s71, s71, 4096
  s_add_u32 m0, m0, 4096
  s_nop 0
  buffer_load_dwordx4 v1, s[28:31], s71 offen offset:0 sc1 lds
  buffer_load_dwordx4 v1, s[28:31], s71 offen offset:1024 sc1 lds
  s_waitcnt vmcnt(6)
  v_cmp_eq_u64 vcc, s[90:91], v[12:13]
  s_nop 0
  s_cmp_eq_u64 vcc, -1
  s_cbranch_scc0 ALrare_97
ALback_98:
  s_mov_b32 s77, 0
  s_lshl_b32 s71, s77, 10
  s_add_u32 s71, s71, s74
  s_add_u32 m0, s76, 16384
  s_barrier
  buffer_load_dwordx4 v1, s[28:31], s71 offen offset:0 sc1 lds
  buffer_load_dwordx4 v1, s[28:31], s71 offen offset:1024 sc1 lds
  buffer_load_dwordx4 v1, s[28:31], s71 offen offset:2048 sc1 lds
  buffer_load_dwordx4 v1, s[28:31], s71 offen offset:3072 sc1 lds
  s_add_u32 s71, s71, 4096
  s_add_u32 m0, m0, 4096
  s_nop 0
  buffer_load_dwordx4 v1, s[28:31], s71 offen offset:0 sc1 lds
  buffer_load_dwordx4 v1, s[28:31], s71 offen offset:1024 sc1 lds
  buffer_load_dwordx4 v1, s[28:31], s71 offen offset:2048 sc1 lds
  buffer_load_dwordx4 v1, s[28:31], s71 offen offset:3072 sc1 lds
  s_mov_b32 s77, 8
  s_lshl_b32 s71, s77, 10
  s_add_u32 s71, s71, s74
  s_add_u32 m0, s76, 32768
  s_barrier
  buffer_load_dwordx4 v1, s[28:31], s71 offen offset:0 sc1 lds
  buffer_load_dwordx4 v1, s[28:31], s71 offen offset:1024 sc1 lds
  buffer_load_dwordx4 v1, s[28:31], s71 offen offset:2048 sc1 lds
  buffer_load_dwordx4 v1, s[28:31], s71 offen offset:3072 sc1 lds
  s_add_u32 s71, s71, 4096
  s_add_u32 m0, m0, 4096
  s_nop 0
  buffer_load_dwordx4 v1, s[28:31], s71 offen offset:0 sc1 lds
  buffer_load_dwordx4 v1, s[28:31], s71 offen offset:1024 sc1 lds
  buffer_load_dwordx4 v1, s[28:31], s71 offen offset:2048 sc1 lds
  buffer_load_dwordx4 v1, s[28:31], s71 offen offset:3072 sc1 lds
  s_mov_b32 s77, 86
  s_lshl_b32 s71, s77, 10
  s_add_u32 s71, s71, s74
  s_add_u32 m0, s76, 49152
  s_waitcnt vmcnt(16)
  s_barrier
  buffer_load_dwordx4 v1, s[28:31], s71 offen offset:0 sc1 lds
  buffer_load_dwordx4 v1, s[28:31], s71 offen offset:1024 sc1 lds
  buffer_load_dwordx4 v1, s[28:31], s71 offen offset:2048 sc1 lds
  buffer_load_dwordx4 v1, s[28:31], s71 offen offset:3072 sc1 lds
  s_add_u32 s71, s71, 4096
  s_add_u32 m0, m0, 4096
  s_nop 0
  buffer_load_dwordx4 v1, s[28:31], s71 offen offset:0 sc1 lds
  buffer_load_dwordx4 v1, s[28:31], s71 offen offset:1024 sc1 lds
  buffer_load_dwordx4 v1, s[28:31], s71 offen offset:2048 sc1 lds
  buffer_load_dwordx4 v1, s[28:31], s71 offen offset:3072 sc1 lds
  s_mov_b32 s77, 94
  s_lshl_b32 s71, s77, 10
  s_add_u32 s71, s71, s74
  s_add_u32 m0, s76, 0
  s_waitcnt vmcnt(16)
  s_barrier
  buffer_load_dwordx4 v1, s[28:31], s71 offen offset:0 sc1 lds
  buffer_load_dwordx4 v1, s[28:31], s71 offen offset:1024 sc1 lds
  buffer_load_dwordx4 v1, s[28:31], s71 offen offset:2048 sc1 lds
  buffer_load_dwordx4 v1, s[28:31], s71 offen offset:3072 sc1 lds
  s_add_u32 s71, s71, 4096
  s_add_u32 m0, m0, 4096
  s_nop 0
  buffer_load_dwordx4 v1, s[28:31], s71 offen offset:0 sc1 lds
  buffer_load_dwordx4 v1, s[28:31], s71 offen offset:1024 sc1 lds
  buffer_load_dwordx4 v1, s[28:31], s71 offen offset:2048 sc1 lds
  buffer_load_dwordx4 v1, s[28:31], s71 offen offset:3072 sc1 lds
  s_mov_b32 s77, 102
  s_lshl_b32 s71, s77, 10
  s_add_u32 s71, s71, s74
  s_add_u32 m0, s76, 16384
  s_waitcnt vmcnt(16)
  s_barrier
  buffer_load_dwordx4 v1, s[28:31], s71 offen offset:0 sc1 lds
  buffer_load_dwordx4 v1, s[28:31], s71 offen offset:1024 sc1 lds
  buffer_load_dwordx4 v1, s[28:31], s71 offen offset:2048 sc1 lds
  buffer_load_dwordx4 v1, s[28:31], s71 offen offset:3072 sc1 lds
  s_add_u32 s71, s71, 4096
  s_add_u32 m0, m0, 4096
  s_nop 0
  buffer_load_dwordx4 v1, s[28:31], s71 offen offset:0 sc1 lds
  buffer_load_dwordx4 v1, s[28:31], s71 offen offset:1024 sc1 lds
  buffer_load_dwordx4 v1, s[28:31], s71 offen offset:2048 sc1 lds
  buffer_load_dwordx4 v1, s[28:31], s71 offen offset:3072 sc1 lds
  s_mov_b32 s77, 110
  s_lshl_b32 s71, s77, 10
  s_add_u32 s71, s71, s74
  s_add_u32 m0, s76, 32768
  s_waitcnt vmcnt(16)
  s_barrier
  buffer_load_dwordx4 v1, s[28:31], s71 offen offset:0 sc1 lds
  buffer_load_dwordx4 v1, s[28:31], s71 offen offset:1024 sc1 lds
  buffer_load_dwordx4 v1, s[28:31], s71 offen offset:2048 sc1 lds
  buffer_load_dwordx4 v1, s[28:31], s71 offen offset:3072 sc1 lds
  s_add_u32 s71, s71, 4096
  s_add_u32 m0, m0, 4096
  s_nop 0
  buffer_load_dwordx4 v1, s[28:31], s71 offen offset:0 sc1 lds
  buffer_load_dwordx4 v1, s[28:31], s71 offen offset:1024 sc1 lds
  buffer_load_dwordx4 v1, s[28:31], s71 offen offset:2048 sc1 lds
  buffer_load_dwordx4 v1, s[28:31], s71 offen offset:3072 sc1 lds
  s_waitcnt vmcnt(16)
  s_barrier
  s_waitcnt vmcnt(8)
  s_barrier
  s_waitcnt vmcnt(0)
  s_barrier
  s_branch ALend_91
ALelse_90:
  v_lshrrev_b32 v2, 3, v0
  v_lshlrev_b32 v2, 10, v2
  v_and_b32 v3, 7, v0
  v_bfe_u32 v4, v0, 4, 1
  v_lshlrev_b32 v4, 2, v4
  v_xor_b32 v3, v3, v4
  v_lshl_add_u32 v112, v3, 4, v2
  s_lshl_b32 s66, s26, 7
  v_add_u32 v112, s66, v112
  v_add_u32 v113, 7168, v112
  v_add_u32 v114, 14336, v112
  v_add_u32 v115, 21504, v112
  s_and_b32 s66, s60, 1
  s_lshl_b32 s74, s66, 16
  s_lshl_b32 s76, s66, 13
  s_cmp_lt_u32 s70, 2
  s_cselect_b32 s78, 0, 0
  s_cmp_lt_u32 s70, 2
  s_cbranch_scc1 ALskip_101
  s_add_u32 s77, s3, 0
  s_and_b32 s77, s77, 7
  s_lshl_b32 s77, s77, 3
  s_add_u32 s77, s77, 16
  s_lshl_b32 s73, s77, 14
  s_add_u32 s73, s73, s74
  s_add_u32 m0, s78, s76
  s_add_u32 m0, m0, 65536
  s_add_u32 s78, s78, 16384
  s_cmp_ge_u32 s78, 98304
  s_cselect_b32 s78, 0, s78
  buffer_load_dwordx4 v112, s[36:39], s73 offen offset:0 lds
  buffer_load_dwordx4 v113, s[36:39], s73 offen offset:1024 lds
  buffer_load_dwordx4 v114, s[36:39], s73 offen offset:2048 lds
  buffer_load_dwordx4 v115, s[36:39], s73 offen offset:3072 lds
  s_add_u32 s73, s73, 32768
  s_add_u32 m0, m0, 4096
  s_nop 0
  buffer_load_dwordx4 v112, s[36:39], s73 offen offset:0 lds
  buffer_load_dwordx4 v113, s[36:39], s73 offen offset:1024 lds
  buffer_load_dwordx4 v114, s[36:39], s73 offen offset:2048 lds
  buffer_load_dwordx4 v115, s[36:39], s73 offen offset:3072 lds
  s_add_u32 s77, s3, 1
  s_and_b32 s77, s77, 7
  s_lshl_b32 s77, s77, 3
  s_add_u32 s77, s77, 16
  s_lshl_b32 s73, s77, 14
  s_add_u32 s73, s73, s74
  s_add_u32 m0, s78, s76
  s_add_u32 m0, m0, 65536
  s_add_u32 s78, s78, 16384
  s_cmp_ge_u32 s78, 98304
  s_cselect_b32 s78, 0, s78
  buffer_load_dwordx4 v112, s[36:39], s73 offen offset:0 lds
  buffer_load_dwordx4 v113, s[36:39], s73 offen offset:1024 lds
  buffer_load_dwordx4 v114, s[36:39], s73 offen offset:2048 lds
  buffer_load_dwordx4 v115, s[36:39], s73 offen offset:3072 lds
  s_add_u32 s73, s73, 32768
  s_add_u32 m0, m0, 4096
  s_nop 0
  buffer_load_dwordx4 v112, s[36:39], s73 offen offset:0 lds
  buffer_load_dwordx4 v113, s[36:39], s73 offen offset:1024 lds
  buffer_load_dwordx4 v114, s[36:39], s73 offen offset:2048 lds
  buffer_load_dwordx4 v115, s[36:39], s73 offen offset:3072 lds
  s_add_u32 s77, s3, 2
  s_and_b32 s77, s77, 7
  s_lshl_b32 s77, s77, 3
  s_add_u32 s77, s77, 16
  s_lshl_b32 s73, s77, 14
  s_add_u32 s73, s73, s74
  s_add_u32 m0, s78, s76
  s_add_u32 m0, m0, 65536
  s_add_u32 s78, s78, 16384
  s_cmp_ge_u32 s78, 98304
  s_cselect_b32 s78, 0, s78
  buffer_load_dwordx4 v112, s[36:39], s73 offen offset:0 lds
  buffer_load_dwordx4 v113, s[36:39], s73 offen offset:1024 lds
  buffer_load_dwordx4 v114, s[36:39], s73 offen offset:2048 lds
  buffer_load_dwordx4 v115, s[36:39], s73 offen offset:3072 lds
  s_add_u32 s73, s73, 32768
  s_add_u32 m0, m0, 4096
  s_nop 0
  buffer_load_dwordx4 v112, s[36:39], s73 offen offset:0 lds
  buffer_load_dwordx4 v113, s[36:39], s73 offen offset:1024 lds
  buffer_load_dwordx4 v114, s[36:39], s73 offen offset:2048 lds
  buffer_load_dwordx4 v115, s[36:39], s73 offen offset:3072 lds
  s_add_u32 s77, s3, 3
  s_and_b32 s77, s77, 7
  s_lshl_b32 s77, s77, 3
  s_add_u32 s77, s77, 16
  s_lshl_b32 s73, s77, 14
  s_add_u32 s73, s73, s74
  s_add_u32 m0, s78, s76
  s_add_u32 m0, m0, 65536
  s_add_u32 s78, s78, 16384
  s_cmp_ge_u32 s78, 98304
  s_cselect_b32 s78, 0, s78
  buffer_load_dwordx4 v112, s[36:39], s73 offen offset:0 lds
  buffer_load_dwordx4 v113, s[36:39], s73 offen offset:1024 lds
  buffer_load_dwordx4 v114, s[36:39], s73 offen offset:2048 lds
  buffer_load_dwordx4 v115, s[36:39], s73 offen offset:3072 lds
  s_add_u32 s73, s73, 32768
  s_add_u32 m0, m0, 4096
  s_nop 0
  buffer_load_dwordx4 v112, s[36:39], s73 offen offset:0 lds
  buffer_load_dwordx4 v113, s[36:39], s73 offen offset:1024 lds
  buffer_load_dwordx4 v114, s[36:39], s73 offen offset:2048 lds
  buffer_load_dwordx4 v115, s[36:39], s73 offen offset:3072 lds
  s_add_u32 s77, s3, 4
  s_and_b32 s77, s77, 7
  s_lshl_b32 s77, s77, 3
  s_add_u32 s77, s77, 16
  s_lshl_b32 s73, s77, 14
  s_add_u32 s73, s73, s74
  s_add_u32 m0, s78, s76
  s_add_u32 m0, m0, 65536
  s_add_u32 s78, s78, 16384
  s_cmp_ge_u32 s78, 98304
  s_cselect_b32 s78, 0, s78
  buffer_load_dwordx4 v112, s[36:39], s73 offen offset:0 lds
  buffer_load_dwordx4 v113, s[36:39], s73 offen offset:1024 lds
  buffer_load_dwordx4 v114, s[36:39], s73 offen offset:2048 lds
  buffer_load_dwordx4 v115, s[36:39], s73 offen offset:3072 lds
  s_add_u32 s73, s73, 32768
  s_add_u32 m0, m0, 4096
  s_nop 0
  buffer_load_dwordx4 v112, s[36:39], s73 offen offset:0 lds
  buffer_load_dwordx4 v113, s[36:39], s73 offen offset:1024 lds
  buffer_load_dwordx4 v114, s[36:39], s73 offen offset:2048 lds
  buffer_load_dwordx4 v115, s[36:39], s73 offen offset:3072 lds
  s_add_u32 s77, s3, 5
  s_and_b32 s77, s77, 7
  s_lshl_b32 s77, s77, 3
  s_add_u32 s77, s77, 16
  s_lshl_b32 s73, s77, 14
  s_add_u32 s73, s73, s74
  s_add_u32 m0, s78, s76
  s_add_u32 m0, m0, 65536
  s_add_u32 s78, s78, 16384
  s_cmp_ge_u32 s78, 98304
  s_cselect_b32 s78, 0, s78
  buffer_load_dwordx4 v112, s[36:39], s73 offen offset:0 lds
  buffer_load_dwordx4 v113, s[36:39], s73 offen offset:1024 lds
  buffer_load_dwordx4 v114, s[36:39], s73 offen offset:2048 lds
  buffer_load_dwordx4 v115, s[36:39], s73 offen offset:3072 lds
  s_add_u32 s73, s73, 32768
  s_add_u32 m0, m0, 4096
  s_nop 0
  buffer_load_dwordx4 v112, s[36:39], s73 offen offset:0 lds
  buffer_load_dwordx4 v113, s[36:39], s73 offen offset:1024 lds
  buffer_load_dwordx4 v114, s[36:39], s73 offen offset:2048 lds
  buffer_load_dwordx4 v115, s[36:39], s73 offen offset:3072 lds
ALskip_101:
  s_waitcnt vmcnt(40)
  s_barrier
  s_add_u32 s77, s3, 6
  s_and_b32 s77, s77, 7
  s_lshl_b32 s77, s77, 3
  s_add_u32 s77, s77, 16
  s_lshl_b32 s73, s77, 14
  s_add_u32 s73, s73, s74
  s_add_u32 m0, s78, s76
  s_add_u32 m0, m0, 65536
  s_add_u32 s78, s78, 16384
  s_cmp_ge_u32 s78, 98304
  s_cselect_b32 s78, 0, s78
  s_waitcnt vmcnt(32)
  s_barrier
  buffer_load_dwordx4 v112, s[36:39], s73 offen offset:0 lds
  buffer_load_dwordx4 v113, s[36:39], s73 offen offset:1024 lds
  buffer_load_dwordx4 v114, s[36:39], s73 offen offset:2048 lds
  buffer_load_dwordx4 v115, s[36:39], s73 offen offset:3072 lds
  s_add_u32 s73, s73, 32768
  s_add_u32 m0, m0, 4096
  s_nop 0
  buffer_load_dwordx4 v112, s[36:39], s73 offen offset:0 lds
  buffer_load_dwordx4 v113, s[36:39], s73 offen offset:1024 lds
  buffer_load_dwordx4 v114, s[36:39], s73 offen offset:2048 lds
  buffer_load_dwordx4 v115, s[36:39], s73 offen offset:3072 lds
  s_add_u32 s77, s3, 7
  s_and_b32 s77, s77, 7
  s_lshl_b32 s77, s77, 3
  s_add_u32 s77, s77, 16
  s_lshl_b32 s73, s77, 14
  s_add_u32 s73, s73, s74
  s_add_u32 m0, s78, s76
  s_add_u32 m0, m0, 65536
  s_add_u32 s78, s78, 16384
  s_cmp_ge_u32 s78, 98304
  s_cselect_b32 s78, 0, s78
  s_waitcnt vmcnt(32)
  s_barrier
  buffer_load_dwordx4 v112, s[36:39], s73 offen offset:0 lds
  buffer_load_dwordx4 v113, s[36:39], s73 offen offset:1024 lds
  buffer_load_dwordx4 v114, s[36:39], s73 offen offset:2048 lds
  buffer_load_dwordx4 v115, s[36:39], s73 offen offset:3072 lds
  s_add_u32 s73, s73, 32768
  s_add_u32 m0, m0, 4096
  s_nop 0
  buffer_load_dwordx4 v112, s[36:39], s73 offen offset:0 lds
  buffer_load_dwordx4 v113, s[36:39], s73 offen offset:1024 lds
  buffer_load_dwordx4 v114, s[36:39], s73 offen offset:2048 lds
  buffer_load_dwordx4 v115, s[36:39], s73 offen offset:3072 lds
  s_mov_b32 s77, 80
  s_lshl_b32 s73, s77, 14
  s_add_u32 s73, s73, s74
  s_add_u32 m0, s78, s76
  s_add_u32 m0, m0, 65536
  s_add_u32 s78, s78, 16384
  s_cmp_ge_u32 s78, 98304
  s_cselect_b32 s78, 0, s78
  s_waitcnt vmcnt(32)
  s_barrier
  buffer_load_dwordx4 v112, s[36:39], s73 offen offset:0 lds
  buffer_load_dwordx4 v113, s[36:39], s73 offen offset:1024 lds
  buffer_load_dwordx4 v114, s[36:39], s73 offen offset:2048 lds
  buffer_load_dwordx4 v115, s[36:39], s73 offen offset:3072 lds
  s_add_u32 s73, s73, 32768
  s_add_u32 m0, m0, 4096
  s_nop 0
  buffer_load_dwordx4 v112, s[36:39], s73 offen offset:0 lds
  buffer_load_dwordx4 v113, s[36:39], s73 offen offset:1024 lds
  buffer_load_dwordx4 v114, s[36:39], s73 offen offset:2048 lds
  buffer_load_dwordx4 v115, s[36:39], s73 offen offset:3072 lds
  s_mov_b32 s77, 0
  s_lshl_b32 s73, s77, 14
  s_add_u32 s73, s73, s74
  s_add_u32 m0, s78, s76
  s_add_u32 m0, m0, 65536
  s_add_u32 s78, s78, 16384
  s_cmp_ge_u32 s78, 98304
  s_cselect_b32 s78, 0, s78
  s_waitcnt vmcnt(32)
  s_barrier
  buffer_load_dwordx4 v112, s[36:39], s73 offen offset:0 lds
  buffer_load_dwordx4 v113, s[36:39], s73 offen offset:1024 lds
  buffer_load_dwordx4 v114, s[36:39], s73 offen offset:2048 lds
  buffer_load_dwordx4 v115, s[36:39], s73 offen offset:3072 lds
  s_add_u32 s73, s73, 32768
  s_add_u32 m0, m0, 4096
  s_nop 0
  buffer_load_dwordx4 v112, s[36:39], s73 offen offset:0 lds
  buffer_load_dwordx4 v113, s[36:39], s73 offen offset:1024 lds
  buffer_load_dwordx4 v114, s[36:39], s73 offen offset:2048 lds
  buffer_load_dwordx4 v115, s[36:39], s73 offen offset:3072 lds
  s_mov_b32 s77, 8
  s_lshl_b32 s73, s77, 14
  s_add_u32 s73, s73, s74
  s_add_u32 m0, s78, s76
  s_add_u32 m0, m0, 65536
  s_add_u32 s78, s78, 16384
  s_cmp_ge_u32 s78, 98304
  s_cselect_b32 s78, 0, s78
  s_waitcnt vmcnt(32)
  s_barrier
  buffer_load_dwordx4 v112, s[36:39], s73 offen offset:0 lds
  buffer_load_dwordx4 v113, s[36:39], s73 offen offset:1024 lds
  buffer_load_dwordx4 v114, s[36:39], s73 offen offset:2048 lds
  buffer_load_dwordx4 v115, s[36:39], s73 offen offset:3072 lds
  s_add_u32 s73, s73, 32768
  s_add_u32 m0, m0, 4096
  s_nop 0
  buffer_load_dwordx4 v112, s[36:39], s73 offen offset:0 lds
  buffer_load_dwordx4 v113, s[36:39], s73 offen offset:1024 lds
  buffer_load_dwordx4 v114, s[36:39], s73 offen offset:2048 lds
  buffer_load_dwordx4 v115, s[36:39], s73 offen offset:3072 lds
  s_mov_b32 s36, s10
  s_mov_b32 s37, s11
  s_mov_b32 s38, 524288
  s_mov_b32 s39, 0x20000
  s_mov_b32 s73, 0
  s_add_u32 s73, s73, s74
  s_add_u32 m0, s78, s76
  s_add_u32 m0, m0, 65536
  s_add_u32 s78, s78, 16384
  s_cmp_ge_u32 s78, 98304
  s_cselect_b32 s78, 0, s78
  s_waitcnt vmcnt(32)
  s_barrier
  buffer_load_dwordx4 v112, s[36:39], s73 offen offset:0 lds
  buffer_load_dwordx4 v113, s[36:39], s73 offen offset:1024 lds
  buffer_load_dwordx4 v114, s[36:39], s73 offen offset:2048 lds
  buffer_load_dwordx4 v115, s[36:39], s73 offen offset:3072 lds
  s_add_u32 s73, s73, 32768
  s_add_u32 m0, m0, 4096
  s_nop 0
  buffer_load_dwordx4 v112, s[36:39], s73 offen offset:0 lds
  buffer_load_dwordx4 v113, s[36:39], s73 offen offset:1024 lds
  buffer_load_dwordx4 v114, s[36:39], s73 offen offset:2048 lds
  buffer_load_dwordx4 v115, s[36:39], s73 offen offset:3072 lds
  s_mov_b32 s73, 131072
  s_add_u32 s73, s73, s74
  s_add_u32 m0, s78, s76
  s_add_u32 m0, m0, 65536
  s_add_u32 s78, s78, 16384
  s_cmp_ge_u32 s78, 98304
  s_cselect_b32 s78, 0, s78
  s_waitcnt vmcnt(32)
  s_barrier
  buffer_load_dwordx4 v112, s[36:39], s73 offen offset:0 lds
  buffer_load_dwordx4 v113, s[36:39], s73 offen offset:1024 lds
  buffer_load_dwordx4 v114, s[36:39], s73 offen offset:2048 lds
  buffer_load_dwordx4 v115, s[36:39], s73 offen offset:3072 lds
  s_add_u32 s73, s73, 32768
  s_add_u32 m0, m0, 4096
  s_nop 0
  buffer_load_dwordx4 v112, s[36:39], s73 offen offset:0 lds
  buffer_load_dwordx4 v113, s[36:39], s73 offen offset:1024 lds
  buffer_load_dwordx4 v114, s[36:39], s73 offen offset:2048 lds
  buffer_load_dwordx4 v115, s[36:39], s73 offen offset:3072 lds
  s_mov_b32 s73, 262144
  s_add_u32 s73, s73, s74
  s_add_u32 m0, s78, s76
  s_add_u32 m0, m0, 65536
  s_add_u32 s78, s78, 16384
  s_cmp_ge_u32 s78, 98304
  s_cselect_b32 s78, 0, s78
  s_waitcnt vmcnt(32)
  s_barrier
  buffer_load_dwordx4 v112, s[36:39], s73 offen offset:0 lds
  buffer_load_dwordx4 v113, s[36:39], s73 offen offset:1024 lds
  buffer_load_dwordx4 v114, s[36:39], s73 offen offset:2048 lds
  buffer_load_dwordx4 v115, s[36:39], s73 offen offset:3072 lds
  s_add_u32 s73, s73, 32768
  s_add_u32 m0, m0, 4096
  s_nop 0
  buffer_load_dwordx4 v112, s[36:39], s73 offen offset:0 lds
  buffer_load_dwordx4 v113, s[36:39], s73 offen offset:1024 lds
  buffer_load_dwordx4 v114, s[36:39], s73 offen offset:2048 lds
  buffer_load_dwordx4 v115, s[36:39], s73 offen offset:3072 lds
  s_mov_b32 s73, 393216
  s_add_u32 s73, s73, s74
  s_add_u32 m0, s78, s76
  s_add_u32 m0, m0, 65536
  s_add_u32 s78, s78, 16384
  s_cmp_ge_u32 s78, 98304
  s_cselect_b32 s78, 0, s78
  s_waitcnt vmcnt(32)
  s_barrier
  buffer_load_dwordx4 v112, s[36:39], s73 offen offset:0 lds
  buffer_load_dwordx4 v113, s[36:39], s73 offen offset:1024 lds
  buffer_load_dwordx4 v114, s[36:39], s73 offen offset:2048 lds
  buffer_load_dwordx4 v115, s[36:39], s73 offen offset:3072 lds
  s_add_u32 s73, s73, 32768
  s_add_u32 m0, m0, 4096
  s_nop 0
  buffer_load_dwordx4 v112, s[36:39], s73 offen offset:0 lds
  buffer_load_dwordx4 v113, s[36:39], s73 offen offset:1024 lds
  buffer_load_dwordx4 v114, s[36:39], s73 offen offset:2048 lds
  buffer_load_dwordx4 v115, s[36:39], s73 offen offset:3072 lds
  s_waitcnt vmcnt(32)
  s_barrier
  s_mov_b32 s32, s4
  s_mov_b32 s33, s5
  s_mov_b32 s34, 2097152
  s_mov_b32 s35, 0x20000
  s_lshl_b32 s73, s27, 16
  s_lshr_b32 s66, s74, 1
  s_add_u32 s73, s73, s66
  s_lshr_b32 s66, s76, 1
  s_add_u32 m0, s66, 114688
  s_nop 0
  buffer_load_dwordx4 v112, s[32:35], s73 offen offset:0 lds
  buffer_load_dwordx4 v113, s[32:35], s73 offen offset:1024 lds
  buffer_load_dwordx4 v114, s[32:35], s73 offen offset:2048 lds
  buffer_load_dwordx4 v115, s[32:35], s73 offen offset:3072 lds
  s_waitcnt vmcnt(28)
  s_barrier
  s_waitcnt vmcnt(20)
  s_barrier
  s_waitcnt vmcnt(12)
  s_barrier
  s_waitcnt vmcnt(0)
  s_barrier
ALend_91:
ALend_87:
parallel_sum__linear_kernel_hedgehog__glu_gated_swiglu__prompt_kernel_end:
  s_endpgm
ALrare_1:
  s_waitcnt lgkmcnt(0)
  s_mov_b32 s56, s22
  s_mov_b32 s57, s23
  s_mov_b32 s58, 256
  s_mov_b32 s59, 0x20000
  s_memrealtime s[90:91]
  s_waitcnt lgkmcnt(0)
  v_mov_b32 v2, s90
  v_mov_b32 v3, s91
  s_mov_b64 exec, 1
  buffer_store_dwordx2 v[2:3], v4, s[56:59], 0 offen offset:128 sc1
  s_mov_b64 exec, -1
  s_branch ALback_2
ALrare_10:
  s_waitcnt vmcnt(8) lgkmcnt(0)
  s_branch ALback_11
ALrare_13:
  s_cmp_lg_u32 s75, 0
  s_cbranch_scc1 ALskip_15
  v_mov_b32 v2, 128
  s_waitcnt vmcnt(8)
  v_readfirstlane_b32 s90, v180
  v_readfirstlane_b32 s91, v181
  s_nop 0
  s_cmp_lg_u64 s[90:91], 0
  s_cbranch_scc0 ALrare_16
ALback_17:
  v_mov_b32 v177, s90
  s_lshl_b32 s66, s60, 11
  s_add_u32 s66, s66, s93
  s_and_b32 s67, s63, 6
  s_lshl_b32 s67, s67, 8
  s_add_u32 s66, s66, s67
  s_and_b32 s67, s63, 1
  s_lshl_b32 s67, s67, 3
  s_add_u32 s66, s66, s67
  s_mov_b64 exec, 0xffffffff
  buffer_store_dwordx2 v[176:177], v1, s[28:31], s66 offen sc1
  s_mov_b64 exec, -1
  s_lshl_b32 s95, s2, 3
  s_add_u32 s95, s95, s60
  s_sub_u32 s66, s95, 1376
  s_cmp_lt_u32 s95, 1376
  s_cselect_b32 s95, s95, s66
  s_cselect_b64 s[52:53], s[18:19], s[10:11]
  s_mov_b32 s66, 524288
  s_cselect_b32 s54, 1409024, s66
  s_mov_b32 s55, 0x20000
  s_lshl_b32 s95, s95, 10
  buffer_load_dwordx4 v[240:243], v1, s[52:55], s95 offen
  s_cmp_lg_u32 s60, 0
  s_cbranch_scc1 ALskip_20
  s_mov_b32 s68, 8
  v_mov_b32 v179, s90
  s_lshl_b32 s66, s68, 11
  s_add_u32 s66, s66, s93
  s_and_b32 s67, s63, 6
  s_lshl_b32 s67, s67, 8
  s_add_u32 s66, s66, s67
  s_and_b32 s67, s63, 1
  s_lshl_b32 s67, s67, 3
  s_add_u32 s66, s66, s67
  s_mov_b64 exec, 0xffffffff
  buffer_store_dwordx2 v[178:179], v1, s[28:31], s66 offen sc1
  s_mov_b64 exec, -1
ALskip_20:
ALskip_15:
  s_cmp_lg_u32 s75, 3
  s_cbranch_scc1 ALskip_21
  s_add_u32 s66, s94, 0
  buffer_load_dwordx4 v[184:187], v1, s[28:31], s66 offen offset:0 sc1
  buffer_load_dwordx4 v[188:191], v1, s[28:31], s66 offen offset:1024 sc1
  s_cmp_lg_u32 s60, 0
  s_cbranch_scc1 ALskip_22
  s_add_u32 s66, s93, 16384
  buffer_load_dwordx4 v[192:195], v1, s[28:31], s66 offen offset:0 sc1
  buffer_load_dwordx4 v[196:199], v1, s[28:31], s66 offen offset:1024 sc1
ALskip_22:
ALskip_21:
  s_cmp_lg_u32 s75, 5
  s_cbranch_scc1 ALskip_23
  v_min_u32 v2, v185, v187
  v_min3_u32 v2, v2, v189, v191
  v_max_u32 v3, v185, v187
  v_max3_u32 v3, v3, v189, v191
  v_cmp_eq_u32 vcc, s90, v2
  v_cmp_eq_u32 s[96:97], s90, v3
  s_nop 0
  s_and_b64 vcc, vcc, s[96:97]
  s_cmp_eq_u64 vcc, -1
  s_cbranch_scc0 ALrare_24
ALback_25:
  v_add_f32 v184, v184, v186
  v_add_f32 v188, v188, v190
  v_add_f32 v184, v184, v188
  v_cvt_pk_bf16_f32 v7, v184, v184
  v_and_b32 v7, 0xffff0000, v7
  v_sub_f32 v7, v184, v7
  v_cvt_pk_bf16_f32 v4, v184, v7
  v_lshlrev_b32 v5, 2, v0
  s_lshl_b32 s66, s60, 8
  s_add_u32 s66, s66, 106752
  v_add_u32 v5, s66, v5
  ds_write_b32 v5, v4
  s_cmp_lg_u32 s60, 0
  s_cbranch_scc1 ALskip_28
  v_min_u32 v2, v193, v195
  v_min3_u32 v2, v2, v197, v199
  v_max_u32 v3, v193, v195
  v_max3_u32 v3, v3, v197, v199
  v_cmp_eq_u32 vcc, s90, v2
  v_cmp_eq_u32 s[96:97], s90, v3
  s_nop 0
  s_and_b64 vcc, vcc, s[96:97]
  s_cmp_eq_u64 vcc, -1
  s_cbranch_scc0 ALrare_29
ALback_30:
  v_add_f32 v192, v192, v194
  v_add_f32 v196, v196, v198
  v_add_f32 v192, v192, v196
  v_cvt_pk_bf16_f32 v7, v192, v192
  v_and_b32 v7, 0xffff0000, v7
  v_sub_f32 v7, v192, v7
  v_cvt_pk_bf16_f32 v4, v192, v7
  ds_write_b32 v5, v4 offset:2048
ALskip_28:
ALskip_23:
  s_branch ALback_14
ALrare_38:
  s_waitcnt vmcnt(10) lgkmcnt(0)
  s_branch ALback_39
ALrare_41:
  s_cmp_lg_u32 s75, 0
  s_cbranch_scc1 ALskip_43
  v_mov_b32 v2, 128
  s_waitcnt vmcnt(9)
  v_readfirstlane_b32 s90, v164
  v_readfirstlane_b32 s91, v165
  s_nop 0
  s_cmp_lg_u64 s[90:91], 0
  s_cbranch_scc0 ALrare_44
ALback_45:
  v_mov_b32 v161, s90
  s_lshl_b32 s66, s60, 11
  s_add_u32 s66, s66, s93
  s_and_b32 s67, s63, 6
  s_lshl_b32 s67, s67, 8
  s_add_u32 s66, s66, s67
  s_and_b32 s67, s63, 1
  s_lshl_b32 s67, s67, 3
  s_add_u32 s66, s66, s67
  s_mov_b64 exec, 0xffffffff
  buffer_store_dwordx2 v[160:161], v1, s[28:31], s66 offen sc1
  s_mov_b64 exec, -1
  s_lshl_b32 s95, s2, 3
  s_add_u32 s95, s95, s60
  s_sub_u32 s66, s95, 1376
  s_cmp_lt_u32 s95, 1376
  s_cselect_b32 s95, s95, s66
  s_cselect_b64 s[52:53], s[18:19], s[10:11]
  s_mov_b32 s66, 524288
  s_cselect_b32 s54, 1409024, s66
  s_mov_b32 s55, 0x20000
  s_lshl_b32 s95, s95, 10
  buffer_load_dwordx4 v[224:227], v1, s[52:55], s95 offen
  v_mov_b32 v157, s90
  v_mov_b32 v159, s90
  s_lshl_b32 s66, s64, 9
  s_add_u32 s66, s66, s88
  s_mov_b64 exec, 0xffffffff
  buffer_store_dwordx4 v[156:159], v1, s[28:31], s66 offen sc1
  s_mov_b64 exec, -1
ALskip_43:
  s_cmp_lg_u32 s75, 3
  s_cbranch_scc1 ALskip_48
  s_add_u32 s66, s94, 0
  buffer_load_dwordx4 v[168:171], v1, s[28:31], s66 offen offset:0 sc1
  buffer_load_dwordx4 v[172:175], v1, s[28:31], s66 offen offset:1024 sc1
  s_add_u32 s66, s88, 0
  buffer_load_dwordx4 v[140:143], v1, s[28:31], s66 offen offset:0 sc1
  buffer_load_dwordx4 v[144:147], v1, s[28:31], s66 offen offset:1024 sc1
  buffer_load_dwordx4 v[148:151], v1, s[28:31], s66 offen offset:2048 sc1
  buffer_load_dwordx4 v[152:155], v1, s[28:31], s66 offen offset:3072 sc1
ALskip_48:
  s_cmp_lg_u32 s75, 5
  s_cbranch_scc1 ALskip_49
  v_min_u32 v2, v169, v171
  v_min3_u32 v2, v2, v173, v175
  v_min3_u32 v2, v2, v141, v143
  v_min3_u32 v2, v2, v145, v147
  v_min3_u32 v2, v2, v149, v151
  v_min3_u32 v2, v2, v153, v155
  v_max_u32 v3, v169, v171
  v_max3_u32 v3, v3, v173, v175
  v_max3_u32 v3, v3, v141, v143
  v_max3_u32 v3, v3, v145, v147
  v_max3_u32 v3, v3, v149, v151
  v_max3_u32 v3, v3, v153, v155
  v_cmp_eq_u32 vcc, s90, v2
  v_cmp_eq_u32 s[96:97], s90, v3
  s_nop 0
  s_and_b64 vcc, vcc, s[96:97]
  s_cmp_eq_u64 vcc, -1
  s_cbranch_scc0 ALrare_50
ALback_51:
  v_add_f32 v168, v168, v170
  v_add_f32 v172, v172, v174
  v_add_f32 v168, v168, v172
  v_cvt_pk_bf16_f32 v7, v168, v168
  v_and_b32 v7, 0xffff0000, v7
  v_sub_f32 v7, v168, v7
  v_cvt_pk_bf16_f32 v4, v168, v7
  v_lshlrev_b32 v5, 2, v0
  s_lshl_b32 s66, s60, 8
  s_add_u32 s66, s66, 106752
  v_add_u32 v5, s66, v5
  ds_write_b32 v5, v4
  v_add_f32 v140, v140, v144
  v_add_f32 v141, v142, v146
  v_add_f32 v148, v148, v152
  v_add_f32 v149, v150, v154
  v_pk_add_f32 v[140:141], v[140:141], v[148:149]
  s_nop 1
  v_permlane32_swap_b32 v140, v141
  v_add_f32 v140, v140, v141
  v_mov_b32 v141, v140
  s_nop 1
  v_permlane32_swap_b32 v140, v141
  v_mul_f32 v140, 0x3b000000, v140
  v_mul_f32 v141, 0x3b000000, v141
  v_fma_f32 v141, -v140, v140, v141
  v_cvt_pk_bf16_f32 v200, -v140, -v140
  v_max_f32 v141, 0, v141
  v_cvt_pk_bf16_f32 v2, v141, v141
  v_and_b32 v2, 0xffff0000, v2
  v_add_f32 v2, 0x3727c5ac, v2
  v_cvt_pk_bf16_f32 v2, v2, v2
  v_and_b32 v2, 0xffff0000, v2
  v_sqrt_f32 v2, v2
  s_nop 0
  v_cvt_pk_bf16_f32 v2, v2, v2
  v_and_b32 v201, 0xffff0000, v2
  v_rcp_f32 v217, v201
  v_and_b32 v5, 31, v0
  v_lshlrev_b32 v5, 3, v5
  s_lshl_b32 s66, s61, 8
  s_add_u32 s66, s66, 109056
  v_add_u32 v5, s66, v5
  ds_write_b64 v5, v[200:201]
ALskip_49:
  s_branch ALback_42
ALrare_58:
  s_mov_b32 s66, 0
ALnsp_60:
  buffer_load_dwordx2 v[220:221], v2, s[56:59], 0 offen sc1
  s_waitcnt vmcnt(0)
  v_readfirstlane_b32 s90, v220
  v_readfirstlane_b32 s91, v221
  s_add_u32 s66, s66, 1
  s_cmp_ge_u32 s66, 0x40000
  s_cbranch_scc1 ALnspd_61
  s_cmp_eq_u64 s[90:91], 0
  s_cbranch_scc1 ALnsp_60
ALnspd_61:
  s_branch ALback_59
ALrare_67:
  s_mov_b32 s67, 0
ALval_69:
  s_add_u32 s66, s81, 0
  buffer_load_dwordx4 v[196:199], v1, s[28:31], s66 offen offset:0 sc1
  buffer_load_dwordx4 v[200:203], v1, s[28:31], s66 offen offset:1024 sc1
  s_add_u32 s66, s79, 0
  buffer_load_dwordx4 v[204:207], v1, s[28:31], s66 offen offset:0 sc1
  buffer_load_dwordx4 v[208:211], v1, s[28:31], s66 offen offset:1024 sc1
  s_waitcnt vmcnt(0)
  v_min_u32 v2, v197, v199
  v_min3_u32 v2, v2, v201, v203
  v_min3_u32 v2, v2, v205, v207
  v_min3_u32 v2, v2, v209, v211
  v_max_u32 v3, v197, v199
  v_max3_u32 v3, v3, v201, v203
  v_max3_u32 v3, v3, v205, v207
  v_max3_u32 v3, v3, v209, v211
  v_cmp_eq_u32 vcc, s90, v2
  v_cmp_eq_u32 s[96:97], s90, v3
  s_nop 0
  s_and_b64 vcc, vcc, s[96:97]
  s_add_u32 s67, s67, 1
  s_cmp_ge_u32 s67, 0x40000
  s_cbranch_scc1 ALvald_70
  s_cmp_eq_u64 vcc, -1
  s_cbranch_scc0 ALval_69
ALvald_70:
  s_branch ALback_68
ALrare_76:
  s_mov_b32 s67, 0
ALval_78:
  s_add_u32 s66, s82, 0
  buffer_load_dwordx4 v[164:167], v1, s[28:31], s66 offen offset:0 sc1
  buffer_load_dwordx4 v[168:171], v1, s[28:31], s66 offen offset:1024 sc1
  s_add_u32 s66, s82, 32768
  buffer_load_dwordx4 v[172:175], v1, s[28:31], s66 offen offset:0 sc1
  buffer_load_dwordx4 v[176:179], v1, s[28:31], s66 offen offset:1024 sc1
  s_waitcnt vmcnt(0)
  v_min_u32 v2, v165, v167
  v_min3_u32 v2, v2, v169, v171
  v_min3_u32 v2, v2, v173, v175
  v_min3_u32 v2, v2, v177, v179
  v_max_u32 v3, v165, v167
  v_max3_u32 v3, v3, v169, v171
  v_max3_u32 v3, v3, v173, v175
  v_max3_u32 v3, v3, v177, v179
  v_cmp_eq_u32 vcc, s90, v2
  v_cmp_eq_u32 s[96:97], s90, v3
  s_nop 0
  s_and_b64 vcc, vcc, s[96:97]
  s_add_u32 s67, s67, 1
  s_cmp_ge_u32 s67, 0x40000
  s_cbranch_scc1 ALvald_79
  s_cmp_eq_u64 vcc, -1
  s_cbranch_scc0 ALval_78
ALvald_79:
  s_branch ALback_77
ALrare_81:
  s_mov_b32 s67, 0
ALval_83:
  s_add_u32 s66, s84, 0
  buffer_load_dwordx4 v[164:167], v1, s[28:31], s66 offen offset:0 sc1
  buffer_load_dwordx4 v[168:171], v1, s[28:31], s66 offen offset:1024 sc1
  s_waitcnt vmcnt(0)
  v_min_u32 v2, v165, v167
  v_min3_u32 v2, v2, v169, v171
  v_max_u32 v3, v165, v167
  v_max3_u32 v3, v3, v169, v171
  v_cmp_eq_u32 vcc, s90, v2
  v_cmp_eq_u32 s[96:97], s90, v3
  s_nop 0
  s_and_b64 vcc, vcc, s[96:97]
  s_add_u32 s67, s67, 1
  s_cmp_ge_u32 s67, 0x40000
  s_cbranch_scc1 ALvald_84
  s_cmp_eq_u64 vcc, -1
  s_cbranch_scc0 ALval_83
ALvald_84:
  s_branch ALback_82
ALrare_88:
  ds_read_b128 v[48:51], v18 offset:2048
  ds_read_b64_tr_b16 v[80:81], v19 offset:4096
  ds_read_b64_tr_b16 v[82:83], v19 offset:5120
  ds_read_b128 v[52:55], v18 offset:3072
  ds_read_b64_tr_b16 v[84:85], v19 offset:6144
  ds_read_b64_tr_b16 v[86:87], v19 offset:7168
  s_branch ALback_89
ALrare_93:
  s_mov_b32 s67, 0
ALspin_95:
  buffer_load_dwordx2 v[12:13], v14, s[28:31], s78 offen sc1
  s_waitcnt vmcnt(0)
  v_cmp_eq_u64 vcc, s[90:91], v[12:13]
  s_add_u32 s67, s67, 1
  s_cmp_ge_u32 s67, 0x40000
  s_cbranch_scc1 ALspind_96
  s_cmp_eq_u64 vcc, -1
  s_cbranch_scc0 ALspin_95
ALspind_96:
  s_branch ALback_94
ALrare_97:
  s_mov_b32 s67, 0
ALspin_99:
  buffer_load_dwordx2 v[12:13], v14, s[28:31], s78 offen sc1
  s_waitcnt vmcnt(0)
  v_cmp_eq_u64 vcc, s[90:91], v[12:13]
  s_add_u32 s67, s67, 1
  s_cmp_ge_u32 s67, 0x40000
  s_cbranch_scc1 ALspind_100
  s_cmp_eq_u64 vcc, -1
  s_cbranch_scc0 ALspin_99
ALspind_100:
  s_branch ALback_98
ALrare_16:
  s_mov_b32 s66, 0
ALnsp_18:
  buffer_load_dwordx2 v[180:181], v2, s[56:59], 0 offen sc1
  s_waitcnt vmcnt(0)
  v_readfirstlane_b32 s90, v180
  v_readfirstlane_b32 s91, v181
  s_add_u32 s66, s66, 1
  s_cmp_ge_u32 s66, 0x40000
  s_cbranch_scc1 ALnspd_19
  s_cmp_eq_u64 s[90:91], 0
  s_cbranch_scc1 ALnsp_18
ALnspd_19:
  s_branch ALback_17
ALrare_24:
  s_mov_b32 s67, 0
ALval_26:
  s_add_u32 s66, s94, 0
  buffer_load_dwordx4 v[184:187], v1, s[28:31], s66 offen offset:0 sc1
  buffer_load_dwordx4 v[188:191], v1, s[28:31], s66 offen offset:1024 sc1
  s_waitcnt vmcnt(0)
  v_min_u32 v2, v185, v187
  v_min3_u32 v2, v2, v189, v191
  v_max_u32 v3, v185, v187
  v_max3_u32 v3, v3, v189, v191
  v_cmp_eq_u32 vcc, s90, v2
  v_cmp_eq_u32 s[96:97], s90, v3
  s_nop 0
  s_and_b64 vcc, vcc, s[96:97]
  s_add_u32 s67, s67, 1
  s_cmp_ge_u32 s67, 0x40000
  s_cbranch_scc1 ALvald_27
  s_cmp_eq_u64 vcc, -1
  s_cbranch_scc0 ALval_26
ALvald_27:
  s_branch ALback_25
ALrare_29:
  s_mov_b32 s67, 0
ALval_31:
  s_add_u32 s66, s93, 16384
  buffer_load_dwordx4 v[192:195], v1, s[28:31], s66 offen offset:0 sc1
  buffer_load_dwordx4 v[196:199], v1, s[28:31], s66 offen offset:1024 sc1
  s_waitcnt vmcnt(0)
  v_min_u32 v2, v193, v195
  v_min3_u32 v2, v2, v197, v199
  v_max_u32 v3, v193, v195
  v_max3_u32 v3, v3, v197, v199
  v_cmp_eq_u32 vcc, s90, v2
  v_cmp_eq_u32 s[96:97], s90, v3
  s_nop 0
  s_and_b64 vcc, vcc, s[96:97]
  s_add_u32 s67, s67, 1
  s_cmp_ge_u32 s67, 0x40000
  s_cbranch_scc1 ALvald_32
  s_cmp_eq_u64 vcc, -1
  s_cbranch_scc0 ALval_31
ALvald_32:
  s_branch ALback_30
ALrare_44:
  s_mov_b32 s66, 0
ALnsp_46:
  buffer_load_dwordx2 v[164:165], v2, s[56:59], 0 offen sc1
  s_waitcnt vmcnt(0)
  v_readfirstlane_b32 s90, v164
  v_readfirstlane_b32 s91, v165
  s_add_u32 s66, s66, 1
  s_cmp_ge_u32 s66, 0x40000
  s_cbranch_scc1 ALnspd_47
  s_cmp_eq_u64 s[90:91], 0
  s_cbranch_scc1 ALnsp_46
ALnspd_47:
  s_branch ALback_45
ALrare_50:
  s_mov_b32 s67, 0
ALval_52:
  s_add_u32 s66, s94, 0
  buffer_load_dwordx4 v[168:171], v1, s[28:31], s66 offen offset:0 sc1
  buffer_load_dwordx4 v[172:175], v1, s[28:31], s66 offen offset:1024 sc1
  s_add_u32 s66, s88, 0
  buffer_load_dwordx4 v[140:143], v1, s[28:31], s66 offen offset:0 sc1
  buffer_load_dwordx4 v[144:147], v1, s[28:31], s66 offen offset:1024 sc1
  buffer_load_dwordx4 v[148:151], v1, s[28:31], s66 offen offset:2048 sc1
  buffer_load_dwordx4 v[152:155], v1, s[28:31], s66 offen offset:3072 sc1
  s_waitcnt vmcnt(0)
  v_min_u32 v2, v169, v171
  v_min3_u32 v2, v2, v173, v175
  v_min3_u32 v2, v2, v141, v143
  v_min3_u32 v2, v2, v145, v147
  v_min3_u32 v2, v2, v149, v151
  v_min3_u32 v2, v2, v153, v155
  v_max_u32 v3, v169, v171
  v_max3_u32 v3, v3, v173, v175
  v_max3_u32 v3, v3, v141, v143
  v_max3_u32 v3, v3, v145, v147
  v_max3_u32 v3, v3, v149, v151
  v_max3_u32 v3, v3, v153, v155
  v_cmp_eq_u32 vcc, s90, v2
  v_cmp_eq_u32 s[96:97], s90, v3
  s_nop 0
  s_and_b64 vcc, vcc, s[96:97]
  s_add_u32 s67, s67, 1
  s_cmp_ge_u32 s67, 0x40000
  s_cbranch_scc1 ALvald_53
  s_cmp_eq_u64 vcc, -1
  s_cbranch_scc0 ALval_52
ALvald_53:
  s_branch ALback_51
parallel_sum__linear_kernel_hedgehog__glu_gated_swiglu__prompt_kernel_last:
  s_endpgm
.section .rodata,"a"
.p2align 6
.amdhsa_kernel parallel_sum__linear_kernel_hedgehog__glu_gated_swiglu__prompt_kernel
  .amdhsa_next_free_vgpr 256
  .amdhsa_next_free_sgpr 102
  .amdhsa_accum_offset 256
  .amdhsa_group_segment_fixed_size 0
  .amdhsa_kernarg_size 88
  .amdhsa_user_sgpr_count 2
  .amdhsa_user_sgpr_kernarg_segment_ptr 1
  .amdhsa_system_sgpr_workgroup_id_x 1
.end_amdhsa_kernel
```
